```python
import torch

def _softmax(x, axis=-1):
    return torch.softmax(x, dim=axis)
def _gelu(x):
    return torch.nn.functional.gelu(x, approximate="tanh")
def _silu(x):
    return torch.nn.functional.silu(x)
def _sigmoid(x):
    return torch.sigmoid(x)
def _layernorm(x, axis=-1, eps=1e-5):
    m = x.mean(dim=axis, keepdim=True)
    v = x.var(dim=axis, keepdim=True, unbiased=False)
    return (x - m) / torch.sqrt(v + eps)
def _scatter_add(tgt, idx, src, axis=0):
    return tgt.clone().index_add_(axis, idx, src)
def _segment_sum(src, seg, n):
    out = torch.zeros((n,) + src.shape[1:], dtype=src.dtype)
    return out.index_add_(0, seg, src)
def _pad(x, pw):
    flat = tuple(v for pair in reversed(pw) for v in pair)
    return torch.nn.functional.pad(x, flat)

kernel_name = 'recurrent_scan__gqa_block_cached__geglu_ffn__decode'

def setup_inputs():

    _w = (lambda a: (lambda t: t.to(torch.bfloat16) if t.is_floating_point() else t)(torch.as_tensor(a)))
    def _A_setup():
        B, Sq, D = 1, 1, 576
        Hq, Hkv, Sk, Dh = 32, 16, 65536, 128
        assert Hq % Hkv == 0, (Hq, Hkv)
        return {
            "x": _w((lambda *s: torch.randn(*s, dtype=torch.bfloat16) * 0.05)(B, Sq, D)),
            "k_cache": _w((lambda *s: torch.randn(*s, dtype=torch.bfloat16) * 1.6)(B, Hkv, Sk, Dh)),
            "v_cache": _w((lambda *s: torch.randn(*s, dtype=torch.bfloat16) * 0.2)(B, Hkv, Sk, Dh)),
            "wq": _w((lambda *s: torch.randn(*s, dtype=torch.bfloat16) * 1.6)(D, Hq * Dh) * (D ** -0.5)),
            "wo": _w((lambda *s: torch.randn(*s, dtype=torch.bfloat16) * 0.2)(Hq * Dh, D) * ((Hq * Dh) ** -0.5)),
        }
    _A_in = _A_setup()

    def _B_setup():
        B, S, D, F = 1, 1, 576, 4608
        return {
            "x": _w((lambda *s: torch.randn(*s, dtype=torch.bfloat16) * 0.05)(B, S, D)),
            "w_gate": _w((lambda *s: torch.randn(*s, dtype=torch.bfloat16) * 0.1)(D, F)),
            "w_up": _w((lambda *s: torch.randn(*s, dtype=torch.bfloat16) * 0.1)(D, F)),
            "w_down": _w((lambda *s: torch.randn(*s, dtype=torch.bfloat16) * 0.1)(F, D)),
        }
    _B_in = _B_setup()

    return {
        "A_x": _A_in["x"],
        "A_k_cache": _A_in["k_cache"],
        "A_v_cache": _A_in["v_cache"],
        "A_wq": _A_in["wq"],
        "A_wo": _A_in["wo"],
        "B_x": _B_in["x"],
        "B_w_gate": _B_in["w_gate"],
        "B_w_up": _B_in["w_up"],
        "B_w_down": _B_in["w_down"],
    }

def reference(A_x, A_k_cache, A_v_cache, A_wq, A_wo, B_x, B_w_gate, B_w_up, B_w_down):
    def _A_ref(x, k_cache, v_cache, wq, wo):
        B, Sq, D = x.shape
        Hq, Dh = 32, 128
        Hkv = k_cache.shape[1]
        rep = Hq // Hkv
        q = (lambda x, *d: x.permute(*d))((x @ wq).reshape(B, Sq, Hq, Dh), 0, 2, 1, 3)
        k = (lambda x, n, axis: torch.repeat_interleave(x, n, dim=axis))(k_cache, rep, axis=1)
        v = (lambda x, n, axis: torch.repeat_interleave(x, n, dim=axis))(v_cache, rep, axis=1)
        scores = torch.einsum("bhqd,bhkd->bhqk", q, k) * (Dh ** -0.5)
        p = _softmax(scores, axis=-1)
        o = torch.einsum("bhqk,bhkd->bhqd", p, v)
        return (lambda x, *d: x.permute(*d))(o, 0, 2, 1, 3).reshape(B, Sq, Hq * Dh) @ wo

    def _B_ref(x, w_gate, w_up, w_down):
        return (_gelu(x @ w_gate) * (x @ w_up)) @ w_down

    x = A_x
    xn = _layernorm(x, axis=-1)
    s = _A_ref(xn, A_k_cache, A_v_cache, A_wq, A_wo)
    g = _silu(_B_ref(xn, B_w_gate, B_w_up, B_w_down))
    return x + s * g
```

```asm
; @launch grid=(256,1,1) block=(384,1,1) lds=7168
.amdgcn_target "amdgcn-amd-amdhsa--gfx950"
.text
.globl recurrent_scan__gqa_block_cached__geglu_ffn__decode_kernel
.p2align 8
.type recurrent_scan__gqa_block_cached__geglu_ffn__decode_kernel,@function
recurrent_scan__gqa_block_cached__geglu_ffn__decode_kernel:
    s_cmp_ge_u32 s2, 256
    s_cbranch_scc1 L_exit
    s_load_dwordx16 s[16:31], s[0:1], 0
    s_load_dwordx8 s[32:39], s[0:1], 64
    v_lshrrev_b32 v1, 6, v0
    v_and_b32 v0, 63, v0
    v_readfirstlane_b32 s3, v1
    s_lshr_b32 s4, s2, 4
    s_and_b32 s5, s2, 15
    v_and_b32 v9, 1, v0
    v_lshlrev_b32 v9, 4, v9
    v_mov_b32 v10, 0xffff
    v_lshlrev_b32 v9, v9, v10
    v_bfe_u32 v10, v0, 1, 2
    v_cmp_eq_u32 vcc, 0, v10
    s_nop 1
    v_cndmask_b32 v2, 0, v9, vcc
    v_cmp_eq_u32 vcc, 1, v10
    s_nop 1
    v_cndmask_b32 v3, 0, v9, vcc
    v_cmp_eq_u32 vcc, 2, v10
    s_nop 1
    v_cndmask_b32 v4, 0, v9, vcc
    v_cmp_eq_u32 vcc, 3, v10
    s_nop 1
    v_cndmask_b32 v5, 0, v9, vcc
    v_lshrrev_b32 v6, 4, v0
    v_bfe_u32 v7, v0, 3, 1
    v_cmp_eq_u32 s[14:15], 1, v7
    s_mov_b32 s6, 0x01000100
    s_mov_b32 s7, 0x03020302
    s_mov_b32 s8, 0x3fb8aa3b
    s_waitcnt lgkmcnt(0)
    s_load_dword s80, s[38:39], 0
    s_mov_b32 s52, s38
    s_and_b32 s53, s39, 0xffff
    s_mov_b32 s54, 2293760
    s_mov_b32 s55, 0x20000
    s_mov_b32 s60, s16
    s_and_b32 s61, s17, 0xffff
    s_mov_b32 s62, 1152
    s_mov_b32 s63, 0x20000
    s_cmp_ge_u32 s3, 4
    s_cbranch_scc1 L_aux
    s_mov_b32 s40, s18
    s_and_b32 s41, s19, 0xffff
    s_mov_b32 s42, 268435456
    s_mov_b32 s43, 0x20000
    s_mov_b32 s44, s20
    s_and_b32 s45, s21, 0xffff
    s_mov_b32 s46, 268435456
    s_mov_b32 s47, 0x20000
    v_and_b32 v11, 15, v0
    v_lshlrev_b32 v11, 6, v11
    v_lshl_add_u32 v9, v6, 4, v11
    v_lshlrev_b32 v10, 4, v0
    s_lshl_b32 s76, s4, 24
    s_lshl_b32 s11, s5, 2
    s_add_u32 s11, s11, s3
    s_mov_b32 s10, 0
    s_mov_b32 s86, 0
    s_mov_b32 s88, 64
    s_mov_b32 s12, s11
    s_lshl_b32 s9, s11, 12
    s_add_u32 s9, s9, s76
    s_add_u32 s10, s10, 1
    s_add_u32 s11, s11, s88
    buffer_load_dwordx4 v[64:67], v9, s[40:43], s9 offen offset:0 nt
    buffer_load_dwordx4 v[68:71], v9, s[40:43], s9 offen offset:1024 nt
    buffer_load_dwordx4 v[72:75], v9, s[40:43], s9 offen offset:2048 nt
    buffer_load_dwordx4 v[76:79], v9, s[40:43], s9 offen offset:3072 nt
    buffer_load_dwordx4 v[80:83], v10, s[44:47], s9 offen offset:0 nt
    s_mov_b32 s48, s24
    s_and_b32 s49, s25, 0xffff
    s_mov_b32 s50, 4718592
    s_mov_b32 s51, 0x20000
    s_mov_b32 s56, s34
    s_and_b32 s57, s35, 0xffff
    s_mov_b32 s58, 1152
    s_mov_b32 s59, 0x20000
    s_lshl_b32 s12, s4, 8
    s_add_u32 s12, s12, 4096
    s_add_u32 s74, s38, s12
    s_addc_u32 s75, s39, 0
    v_mov_b32 v28, 0
    v_mov_b32 v29, 0
    v_mov_b32 v30, 0
    v_mov_b32 v31, 0
    v_mov_b32 v32, 0xff000000
    v_mov_b32 v33, 0
    v_and_b32 v8, 1, v0
    v_lshl_add_u32 v8, v6, 1, v8
    v_mul_u32_u24 v8, 9216, v8
    v_bfe_u32 v44, v0, 1, 3
    v_lshl_add_u32 v8, v44, 4, v8
    s_lshl_b32 s81, s4, 8
    s_lshl_b32 s82, s3, 6
    s_add_u32 s81, s81, s82
    s_mul_i32 s81, s81, 1152
    s_lshl_b32 s82, s5, 7
    s_add_u32 s81, s81, s82
    s_cmp_ge_u32 s5, 9
    s_cselect_b32 s81, 1073741824, s81
    s_add_u32 s82, s81, 4608
    s_waitcnt vmcnt(4)
    buffer_load_dwordx4 v[84:87], v10, s[44:47], s9 offen offset:1024 nt
    s_waitcnt vmcnt(4)
    buffer_load_dwordx4 v[88:91], v10, s[44:47], s9 offen offset:2048 nt
    s_waitcnt vmcnt(4)
    buffer_load_dwordx4 v[92:95], v10, s[44:47], s9 offen offset:3072 nt
    s_mov_b32 s12, s11
    s_lshl_b32 s9, s11, 12
    s_add_u32 s9, s9, s76
    s_add_u32 s10, s10, 1
    s_add_u32 s11, s11, s88
    s_waitcnt vmcnt(4)
    buffer_load_dwordx4 v[96:99], v9, s[40:43], s9 offen offset:0 nt
    s_waitcnt vmcnt(4)
    buffer_load_dwordx4 v[100:103], v9, s[40:43], s9 offen offset:1024 nt
    s_waitcnt vmcnt(4)
    buffer_load_dwordx4 v[104:107], v9, s[40:43], s9 offen offset:2048 nt
    s_waitcnt vmcnt(4)
    buffer_load_dwordx4 v[108:111], v9, s[40:43], s9 offen offset:3072 nt
    s_waitcnt vmcnt(4)
    buffer_load_dwordx4 v[112:115], v10, s[44:47], s9 offen offset:0 nt
    s_waitcnt vmcnt(4)
    buffer_load_dwordx4 v[116:119], v10, s[44:47], s9 offen offset:1024 nt
    s_waitcnt vmcnt(4)
    buffer_load_dwordx4 v[120:123], v10, s[44:47], s9 offen offset:2048 nt
    s_waitcnt vmcnt(4)
    buffer_load_dwordx4 v[124:127], v10, s[44:47], s9 offen offset:3072 nt
    s_mov_b32 s12, s11
    s_lshl_b32 s9, s11, 12
    s_add_u32 s9, s9, s76
    s_add_u32 s10, s10, 1
    s_add_u32 s11, s11, s88
    s_waitcnt vmcnt(4)
    buffer_load_dwordx4 v[128:131], v9, s[40:43], s9 offen offset:0 nt
    s_waitcnt vmcnt(4)
    buffer_load_dwordx4 v[132:135], v9, s[40:43], s9 offen offset:1024 nt
    s_waitcnt vmcnt(4)
    buffer_load_dwordx4 v[136:139], v9, s[40:43], s9 offen offset:2048 nt
    s_waitcnt vmcnt(4)
    buffer_load_dwordx4 v[140:143], v9, s[40:43], s9 offen offset:3072 nt
    s_waitcnt vmcnt(4)
    buffer_load_dwordx4 v[144:147], v10, s[44:47], s9 offen offset:0 nt
    s_waitcnt vmcnt(4)
    buffer_load_dwordx4 v[148:151], v10, s[44:47], s9 offen offset:1024 nt
    s_waitcnt vmcnt(4)
    buffer_load_dwordx4 v[152:155], v10, s[44:47], s9 offen offset:2048 nt
    s_waitcnt vmcnt(4)
    buffer_load_dwordx4 v[156:159], v10, s[44:47], s9 offen offset:3072 nt
    s_mov_b32 s12, s11
    s_lshl_b32 s9, s11, 12
    s_add_u32 s9, s9, s76
    s_add_u32 s10, s10, 1
    s_add_u32 s11, s11, s88
    s_waitcnt vmcnt(4)
    buffer_load_dwordx4 v[160:163], v9, s[40:43], s9 offen offset:0 nt
    s_waitcnt vmcnt(4)
    buffer_load_dwordx4 v[164:167], v9, s[40:43], s9 offen offset:1024 nt
    s_waitcnt vmcnt(4)
    buffer_load_dwordx4 v[168:171], v9, s[40:43], s9 offen offset:2048 nt
    s_waitcnt vmcnt(4)
    buffer_load_dwordx4 v[172:175], v9, s[40:43], s9 offen offset:3072 nt
    s_waitcnt vmcnt(4)
    buffer_load_dwordx4 v[176:179], v10, s[44:47], s9 offen offset:0 nt
    s_waitcnt vmcnt(4)
    buffer_load_dwordx4 v[180:183], v10, s[44:47], s9 offen offset:1024 nt
    s_waitcnt vmcnt(4)
    buffer_load_dwordx4 v[184:187], v10, s[44:47], s9 offen offset:2048 nt
    s_waitcnt vmcnt(4)
    buffer_load_dwordx4 v[188:191], v10, s[44:47], s9 offen offset:3072 nt
    s_mov_b32 s12, s11
    s_lshl_b32 s9, s11, 12
    s_add_u32 s9, s9, s76
    s_add_u32 s10, s10, 1
    s_add_u32 s11, s11, s88
    s_waitcnt vmcnt(4)
    buffer_load_dwordx4 v[192:195], v9, s[40:43], s9 offen offset:0 nt
    s_waitcnt vmcnt(4)
    buffer_load_dwordx4 v[196:199], v9, s[40:43], s9 offen offset:1024 nt
    s_waitcnt vmcnt(4)
    buffer_load_dwordx4 v[200:203], v9, s[40:43], s9 offen offset:2048 nt
    s_waitcnt vmcnt(4)
    buffer_load_dwordx4 v[204:207], v9, s[40:43], s9 offen offset:3072 nt
    s_waitcnt vmcnt(4)
    buffer_load_dwordx4 v[208:211], v10, s[44:47], s9 offen offset:0 nt
    s_waitcnt vmcnt(4)
    buffer_load_dwordx4 v[212:215], v10, s[44:47], s9 offen offset:1024 nt
    s_waitcnt vmcnt(4)
    buffer_load_dwordx4 v[216:219], v10, s[44:47], s9 offen offset:2048 nt
    s_waitcnt vmcnt(4)
    buffer_load_dwordx4 v[220:223], v10, s[44:47], s9 offen offset:3072 nt
    v_lshlrev_b32 v11, 8, v7
    v_lshl_add_u32 v11, v6, 4, v11
    v_and_b32 v44, 3, v0
    v_lshl_add_u32 v11, v44, 6, v11
    s_barrier
    ds_read_b128 v[12:15], v11 offset:1280
    s_waitcnt lgkmcnt(0)
    s_mul_i32 s79, s80, 0x9e3779b1
    s_add_u32 s79, s79, 0x7f4a7c15
    s_mov_b32 s12, s11
    s_lshl_b32 s9, s11, 12
    s_add_u32 s9, s9, s76
    s_add_u32 s10, s10, 1
    s_add_u32 s11, s11, s88
    s_waitcnt vmcnt(32)
    v_mfma_f32_16x16x32_bf16 v[20:23], v[64:67], v[12:15], 0
    v_mfma_f32_16x16x32_bf16 v[24:27], v[68:71], v[12:15], 0
    v_mfma_f32_16x16x32_bf16 v[48:51], v[72:75], v[12:15], 0
    v_mfma_f32_16x16x32_bf16 v[52:55], v[76:79], v[12:15], 0
    s_waitcnt vmcnt(4)
    buffer_load_dwordx4 v[224:227], v9, s[40:43], s9 offen offset:0 nt
    s_nop 4
    v_mov_b32_dpp v36, v20 quad_perm:[0,0,0,0] row_mask:0xf bank_mask:0xf
    v_add_f32_dpp v36, v21, v36 quad_perm:[1,1,1,1] row_mask:0xf bank_mask:0xf
    v_add_f32_dpp v36, v22, v36 quad_perm:[2,2,2,2] row_mask:0xf bank_mask:0xf
    v_add_f32_dpp v36, v23, v36 quad_perm:[3,3,3,3] row_mask:0xf bank_mask:0xf
    v_mov_b32_dpp v37, v24 quad_perm:[0,0,0,0] row_mask:0xf bank_mask:0xf
    v_add_f32_dpp v37, v25, v37 quad_perm:[1,1,1,1] row_mask:0xf bank_mask:0xf
    v_add_f32_dpp v37, v26, v37 quad_perm:[2,2,2,2] row_mask:0xf bank_mask:0xf
    v_add_f32_dpp v37, v27, v37 quad_perm:[3,3,3,3] row_mask:0xf bank_mask:0xf
    v_mov_b32_dpp v38, v48 quad_perm:[0,0,0,0] row_mask:0xf bank_mask:0xf
    v_add_f32_dpp v38, v49, v38 quad_perm:[1,1,1,1] row_mask:0xf bank_mask:0xf
    v_add_f32_dpp v38, v50, v38 quad_perm:[2,2,2,2] row_mask:0xf bank_mask:0xf
    v_add_f32_dpp v38, v51, v38 quad_perm:[3,3,3,3] row_mask:0xf bank_mask:0xf
    v_mov_b32_dpp v39, v52 quad_perm:[0,0,0,0] row_mask:0xf bank_mask:0xf
    v_add_f32_dpp v39, v53, v39 quad_perm:[1,1,1,1] row_mask:0xf bank_mask:0xf
    v_add_f32_dpp v39, v54, v39 quad_perm:[2,2,2,2] row_mask:0xf bank_mask:0xf
    v_add_f32_dpp v39, v55, v39 quad_perm:[3,3,3,3] row_mask:0xf bank_mask:0xf
    v_cvt_pk_bf16_f32 v44, v36, v37
    v_cvt_pk_bf16_f32 v45, v38, v39
    v_lshlrev_b32 v36, 16, v44
    v_and_b32 v37, 0xffff0000, v44
    v_lshlrev_b32 v38, 16, v45
    v_and_b32 v39, 0xffff0000, v45
    v_mul_f32 v36, 0x3db504f3, v36
    v_mul_f32 v37, 0x3db504f3, v37
    v_mul_f32 v38, 0x3db504f3, v38
    v_mul_f32 v39, 0x3db504f3, v39
    v_cvt_pk_bf16_f32 v44, v36, v37
    v_cvt_pk_bf16_f32 v45, v38, v39
    v_lshlrev_b32 v36, 16, v44
    v_and_b32 v37, 0xffff0000, v44
    v_lshlrev_b32 v38, 16, v45
    v_and_b32 v39, 0xffff0000, v45
    v_mul_f32 v36, s8, v36
    v_mul_f32 v37, s8, v37
    v_mul_f32 v38, s8, v38
    v_mul_f32 v39, s8, v39
    v_floor_f32 v20, v36
    v_floor_f32 v21, v37
    v_floor_f32 v22, v38
    v_floor_f32 v23, v39
    v_max3_f32 v44, v20, v21, v22
    v_max3_f32 v44, v44, v23, v32
    v_sub_f32 v40, v36, v20
    v_sub_f32 v41, v37, v21
    v_sub_f32 v42, v38, v22
    v_sub_f32 v43, v39, v23
    v_mov_b32 v45, v44
    s_nop 1
    v_permlane16_swap_b32 v44, v45
    s_nop 1
    v_max_f32 v44, v44, v45
    v_mov_b32 v45, v44
    s_nop 1
    v_permlane32_swap_b32 v44, v45
    s_nop 1
    v_max_f32 v44, v44, v45
    v_exp_f32 v40, v40
    v_exp_f32 v41, v41
    v_exp_f32 v42, v42
    v_exp_f32 v43, v43
    v_sub_f32 v45, v32, v44
    v_cvt_i32_f32 v45, v45
    v_mov_b32 v32, v44
    v_sub_f32 v20, v20, v44
    v_sub_f32 v21, v21, v44
    v_sub_f32 v22, v22, v44
    v_sub_f32 v23, v23, v44
    v_cvt_i32_f32 v20, v20
    v_cvt_i32_f32 v21, v21
    v_cvt_i32_f32 v22, v22
    v_cvt_i32_f32 v23, v23
    s_waitcnt vmcnt(4)
    buffer_load_dwordx4 v[228:231], v9, s[40:43], s9 offen offset:1024 nt
    v_ldexp_f32 v40, v40, v20
    v_ldexp_f32 v41, v41, v21
    v_ldexp_f32 v42, v42, v22
    v_ldexp_f32 v43, v43, v23
    v_ldexp_f32 v28, v28, v45
    v_ldexp_f32 v29, v29, v45
    v_ldexp_f32 v30, v30, v45
    v_ldexp_f32 v31, v31, v45
    v_ldexp_f32 v33, v33, v45
    v_add_f32 v46, v40, v41
    v_add_f32 v47, v42, v43
    v_add_f32 v46, v46, v47
    v_add_f32 v33, v33, v46
    v_cvt_pk_bf16_f32 v34, v40, v40
    v_and_b32 v48, v2, v34
    v_and_b32 v49, v3, v34
    v_and_b32 v50, v4, v34
    v_and_b32 v51, v5, v34
    v_cvt_pk_bf16_f32 v35, v41, v41
    v_and_b32 v52, v2, v35
    v_and_b32 v53, v3, v35
    v_and_b32 v54, v4, v35
    v_and_b32 v55, v5, v35
    v_cvt_pk_bf16_f32 v34, v42, v42
    v_and_b32 v56, v2, v34
    v_and_b32 v57, v3, v34
    v_and_b32 v58, v4, v34
    v_and_b32 v59, v5, v34
    v_cvt_pk_bf16_f32 v35, v43, v43
    v_and_b32 v60, v2, v35
    v_and_b32 v61, v3, v35
    v_and_b32 v62, v4, v35
    v_and_b32 v63, v5, v35
    s_nop 1
    v_mfma_f32_16x16x32_bf16 v[28:31], v[80:83], v[48:51], v[28:31]
    v_mfma_f32_16x16x32_bf16 v[28:31], v[84:87], v[52:55], v[28:31]
    v_mfma_f32_16x16x32_bf16 v[28:31], v[88:91], v[56:59], v[28:31]
    v_mfma_f32_16x16x32_bf16 v[28:31], v[92:95], v[60:63], v[28:31]
    s_waitcnt vmcnt(26)
    v_mfma_f32_16x16x32_bf16 v[20:23], v[96:99], v[12:15], 0
    v_mfma_f32_16x16x32_bf16 v[24:27], v[100:103], v[12:15], 0
    v_mfma_f32_16x16x32_bf16 v[48:51], v[104:107], v[12:15], 0
    v_mfma_f32_16x16x32_bf16 v[52:55], v[108:111], v[12:15], 0
    s_waitcnt vmcnt(4)
    buffer_load_dwordx4 v[232:235], v9, s[40:43], s9 offen offset:2048 nt
    s_nop 4
    v_mov_b32_dpp v36, v20 quad_perm:[0,0,0,0] row_mask:0xf bank_mask:0xf
    v_add_f32_dpp v36, v21, v36 quad_perm:[1,1,1,1] row_mask:0xf bank_mask:0xf
    v_add_f32_dpp v36, v22, v36 quad_perm:[2,2,2,2] row_mask:0xf bank_mask:0xf
    v_add_f32_dpp v36, v23, v36 quad_perm:[3,3,3,3] row_mask:0xf bank_mask:0xf
    v_mov_b32_dpp v37, v24 quad_perm:[0,0,0,0] row_mask:0xf bank_mask:0xf
    v_add_f32_dpp v37, v25, v37 quad_perm:[1,1,1,1] row_mask:0xf bank_mask:0xf
    v_add_f32_dpp v37, v26, v37 quad_perm:[2,2,2,2] row_mask:0xf bank_mask:0xf
    v_add_f32_dpp v37, v27, v37 quad_perm:[3,3,3,3] row_mask:0xf bank_mask:0xf
    v_mov_b32_dpp v38, v48 quad_perm:[0,0,0,0] row_mask:0xf bank_mask:0xf
    v_add_f32_dpp v38, v49, v38 quad_perm:[1,1,1,1] row_mask:0xf bank_mask:0xf
    v_add_f32_dpp v38, v50, v38 quad_perm:[2,2,2,2] row_mask:0xf bank_mask:0xf
    v_add_f32_dpp v38, v51, v38 quad_perm:[3,3,3,3] row_mask:0xf bank_mask:0xf
    v_mov_b32_dpp v39, v52 quad_perm:[0,0,0,0] row_mask:0xf bank_mask:0xf
    v_add_f32_dpp v39, v53, v39 quad_perm:[1,1,1,1] row_mask:0xf bank_mask:0xf
    v_add_f32_dpp v39, v54, v39 quad_perm:[2,2,2,2] row_mask:0xf bank_mask:0xf
    v_add_f32_dpp v39, v55, v39 quad_perm:[3,3,3,3] row_mask:0xf bank_mask:0xf
    v_cvt_pk_bf16_f32 v44, v36, v37
    v_cvt_pk_bf16_f32 v45, v38, v39
    v_lshlrev_b32 v36, 16, v44
    v_and_b32 v37, 0xffff0000, v44
    v_lshlrev_b32 v38, 16, v45
    v_and_b32 v39, 0xffff0000, v45
    v_mul_f32 v36, 0x3db504f3, v36
    v_mul_f32 v37, 0x3db504f3, v37
    v_mul_f32 v38, 0x3db504f3, v38
    v_mul_f32 v39, 0x3db504f3, v39
    v_cvt_pk_bf16_f32 v44, v36, v37
    v_cvt_pk_bf16_f32 v45, v38, v39
    v_lshlrev_b32 v36, 16, v44
    v_and_b32 v37, 0xffff0000, v44
    v_lshlrev_b32 v38, 16, v45
    v_and_b32 v39, 0xffff0000, v45
    v_mul_f32 v36, s8, v36
    v_mul_f32 v37, s8, v37
    v_mul_f32 v38, s8, v38
    v_mul_f32 v39, s8, v39
    v_floor_f32 v20, v36
    v_floor_f32 v21, v37
    v_floor_f32 v22, v38
    v_floor_f32 v23, v39
    v_max3_f32 v44, v20, v21, v22
    v_max3_f32 v44, v44, v23, v32
    v_sub_f32 v40, v36, v20
    v_sub_f32 v41, v37, v21
    v_sub_f32 v42, v38, v22
    v_sub_f32 v43, v39, v23
    v_mov_b32 v45, v44
    s_nop 1
    v_permlane16_swap_b32 v44, v45
    s_nop 1
    v_max_f32 v44, v44, v45
    v_mov_b32 v45, v44
    s_nop 1
    v_permlane32_swap_b32 v44, v45
    s_nop 1
    v_max_f32 v44, v44, v45
    v_exp_f32 v40, v40
    v_exp_f32 v41, v41
    v_exp_f32 v42, v42
    v_exp_f32 v43, v43
    v_sub_f32 v45, v32, v44
    v_cvt_i32_f32 v45, v45
    v_mov_b32 v32, v44
    v_sub_f32 v20, v20, v44
    v_sub_f32 v21, v21, v44
    v_sub_f32 v22, v22, v44
    v_sub_f32 v23, v23, v44
    v_cvt_i32_f32 v20, v20
    v_cvt_i32_f32 v21, v21
    v_cvt_i32_f32 v22, v22
    v_cvt_i32_f32 v23, v23
    s_waitcnt vmcnt(4)
    buffer_load_dwordx4 v[236:239], v9, s[40:43], s9 offen offset:3072 nt
    v_ldexp_f32 v40, v40, v20
    v_ldexp_f32 v41, v41, v21
    v_ldexp_f32 v42, v42, v22
    v_ldexp_f32 v43, v43, v23
    v_ldexp_f32 v28, v28, v45
    v_ldexp_f32 v29, v29, v45
    v_ldexp_f32 v30, v30, v45
    v_ldexp_f32 v31, v31, v45
    v_ldexp_f32 v33, v33, v45
    v_add_f32 v46, v40, v41
    v_add_f32 v47, v42, v43
    v_add_f32 v46, v46, v47
    v_add_f32 v33, v33, v46
    v_cvt_pk_bf16_f32 v34, v40, v40
    v_and_b32 v48, v2, v34
    v_and_b32 v49, v3, v34
    v_and_b32 v50, v4, v34
    v_and_b32 v51, v5, v34
    v_cvt_pk_bf16_f32 v35, v41, v41
    v_and_b32 v52, v2, v35
    v_and_b32 v53, v3, v35
    v_and_b32 v54, v4, v35
    v_and_b32 v55, v5, v35
    v_cvt_pk_bf16_f32 v34, v42, v42
    v_and_b32 v56, v2, v34
    v_and_b32 v57, v3, v34
    v_and_b32 v58, v4, v34
    v_and_b32 v59, v5, v34
    v_cvt_pk_bf16_f32 v35, v43, v43
    v_and_b32 v60, v2, v35
    v_and_b32 v61, v3, v35
    v_and_b32 v62, v4, v35
    v_and_b32 v63, v5, v35
    s_nop 1
    v_mfma_f32_16x16x32_bf16 v[28:31], v[112:115], v[48:51], v[28:31]
    v_mfma_f32_16x16x32_bf16 v[28:31], v[116:119], v[52:55], v[28:31]
    v_mfma_f32_16x16x32_bf16 v[28:31], v[120:123], v[56:59], v[28:31]
    v_mfma_f32_16x16x32_bf16 v[28:31], v[124:127], v[60:63], v[28:31]
    s_waitcnt vmcnt(20)
    v_mfma_f32_16x16x32_bf16 v[20:23], v[128:131], v[12:15], 0
    v_mfma_f32_16x16x32_bf16 v[24:27], v[132:135], v[12:15], 0
    v_mfma_f32_16x16x32_bf16 v[48:51], v[136:139], v[12:15], 0
    v_mfma_f32_16x16x32_bf16 v[52:55], v[140:143], v[12:15], 0
    s_waitcnt vmcnt(4)
    buffer_load_dwordx4 v[240:243], v10, s[44:47], s9 offen offset:0 nt
    s_nop 4
    v_mov_b32_dpp v36, v20 quad_perm:[0,0,0,0] row_mask:0xf bank_mask:0xf
    v_add_f32_dpp v36, v21, v36 quad_perm:[1,1,1,1] row_mask:0xf bank_mask:0xf
    v_add_f32_dpp v36, v22, v36 quad_perm:[2,2,2,2] row_mask:0xf bank_mask:0xf
    v_add_f32_dpp v36, v23, v36 quad_perm:[3,3,3,3] row_mask:0xf bank_mask:0xf
    v_mov_b32_dpp v37, v24 quad_perm:[0,0,0,0] row_mask:0xf bank_mask:0xf
    v_add_f32_dpp v37, v25, v37 quad_perm:[1,1,1,1] row_mask:0xf bank_mask:0xf
    v_add_f32_dpp v37, v26, v37 quad_perm:[2,2,2,2] row_mask:0xf bank_mask:0xf
    v_add_f32_dpp v37, v27, v37 quad_perm:[3,3,3,3] row_mask:0xf bank_mask:0xf
    v_mov_b32_dpp v38, v48 quad_perm:[0,0,0,0] row_mask:0xf bank_mask:0xf
    v_add_f32_dpp v38, v49, v38 quad_perm:[1,1,1,1] row_mask:0xf bank_mask:0xf
    v_add_f32_dpp v38, v50, v38 quad_perm:[2,2,2,2] row_mask:0xf bank_mask:0xf
    v_add_f32_dpp v38, v51, v38 quad_perm:[3,3,3,3] row_mask:0xf bank_mask:0xf
    v_mov_b32_dpp v39, v52 quad_perm:[0,0,0,0] row_mask:0xf bank_mask:0xf
    v_add_f32_dpp v39, v53, v39 quad_perm:[1,1,1,1] row_mask:0xf bank_mask:0xf
    v_add_f32_dpp v39, v54, v39 quad_perm:[2,2,2,2] row_mask:0xf bank_mask:0xf
    v_add_f32_dpp v39, v55, v39 quad_perm:[3,3,3,3] row_mask:0xf bank_mask:0xf
    v_cvt_pk_bf16_f32 v44, v36, v37
    v_cvt_pk_bf16_f32 v45, v38, v39
    v_lshlrev_b32 v36, 16, v44
    v_and_b32 v37, 0xffff0000, v44
    v_lshlrev_b32 v38, 16, v45
    v_and_b32 v39, 0xffff0000, v45
    v_mul_f32 v36, 0x3db504f3, v36
    v_mul_f32 v37, 0x3db504f3, v37
    v_mul_f32 v38, 0x3db504f3, v38
    v_mul_f32 v39, 0x3db504f3, v39
    v_cvt_pk_bf16_f32 v44, v36, v37
    v_cvt_pk_bf16_f32 v45, v38, v39
    v_lshlrev_b32 v36, 16, v44
    v_and_b32 v37, 0xffff0000, v44
    v_lshlrev_b32 v38, 16, v45
    v_and_b32 v39, 0xffff0000, v45
    v_mul_f32 v36, s8, v36
    v_mul_f32 v37, s8, v37
    v_mul_f32 v38, s8, v38
    v_mul_f32 v39, s8, v39
    v_floor_f32 v20, v36
    v_floor_f32 v21, v37
    v_floor_f32 v22, v38
    v_floor_f32 v23, v39
    v_max3_f32 v44, v20, v21, v22
    v_max3_f32 v44, v44, v23, v32
    v_sub_f32 v40, v36, v20
    v_sub_f32 v41, v37, v21
    v_sub_f32 v42, v38, v22
    v_sub_f32 v43, v39, v23
    v_mov_b32 v45, v44
    s_nop 1
    v_permlane16_swap_b32 v44, v45
    s_nop 1
    v_max_f32 v44, v44, v45
    v_mov_b32 v45, v44
    s_nop 1
    v_permlane32_swap_b32 v44, v45
    s_nop 1
    v_max_f32 v44, v44, v45
    v_exp_f32 v40, v40
    v_exp_f32 v41, v41
    v_exp_f32 v42, v42
    v_exp_f32 v43, v43
    v_sub_f32 v45, v32, v44
    v_cvt_i32_f32 v45, v45
    v_mov_b32 v32, v44
    v_sub_f32 v20, v20, v44
    v_sub_f32 v21, v21, v44
    v_sub_f32 v22, v22, v44
    v_sub_f32 v23, v23, v44
    v_cvt_i32_f32 v20, v20
    v_cvt_i32_f32 v21, v21
    v_cvt_i32_f32 v22, v22
    v_cvt_i32_f32 v23, v23
    s_waitcnt vmcnt(4)
    buffer_load_dwordx4 v[244:247], v10, s[44:47], s9 offen offset:1024 nt
    v_ldexp_f32 v40, v40, v20
    v_ldexp_f32 v41, v41, v21
    v_ldexp_f32 v42, v42, v22
    v_ldexp_f32 v43, v43, v23
    v_ldexp_f32 v28, v28, v45
    v_ldexp_f32 v29, v29, v45
    v_ldexp_f32 v30, v30, v45
    v_ldexp_f32 v31, v31, v45
    v_ldexp_f32 v33, v33, v45
    v_add_f32 v46, v40, v41
    v_add_f32 v47, v42, v43
    v_add_f32 v46, v46, v47
    v_add_f32 v33, v33, v46
    v_cvt_pk_bf16_f32 v34, v40, v40
    v_and_b32 v48, v2, v34
    v_and_b32 v49, v3, v34
    v_and_b32 v50, v4, v34
    v_and_b32 v51, v5, v34
    v_cvt_pk_bf16_f32 v35, v41, v41
    v_and_b32 v52, v2, v35
    v_and_b32 v53, v3, v35
    v_and_b32 v54, v4, v35
    v_and_b32 v55, v5, v35
    v_cvt_pk_bf16_f32 v34, v42, v42
    v_and_b32 v56, v2, v34
    v_and_b32 v57, v3, v34
    v_and_b32 v58, v4, v34
    v_and_b32 v59, v5, v34
    v_cvt_pk_bf16_f32 v35, v43, v43
    v_and_b32 v60, v2, v35
    v_and_b32 v61, v3, v35
    v_and_b32 v62, v4, v35
    v_and_b32 v63, v5, v35
    s_nop 1
    v_mfma_f32_16x16x32_bf16 v[28:31], v[144:147], v[48:51], v[28:31]
    v_mfma_f32_16x16x32_bf16 v[28:31], v[148:151], v[52:55], v[28:31]
    v_mfma_f32_16x16x32_bf16 v[28:31], v[152:155], v[56:59], v[28:31]
    v_mfma_f32_16x16x32_bf16 v[28:31], v[156:159], v[60:63], v[28:31]
    s_waitcnt vmcnt(14)
    v_mfma_f32_16x16x32_bf16 v[20:23], v[160:163], v[12:15], 0
    v_mfma_f32_16x16x32_bf16 v[24:27], v[164:167], v[12:15], 0
    v_mfma_f32_16x16x32_bf16 v[48:51], v[168:171], v[12:15], 0
    v_mfma_f32_16x16x32_bf16 v[52:55], v[172:175], v[12:15], 0
    s_waitcnt vmcnt(4)
    buffer_load_dwordx4 v[248:251], v10, s[44:47], s9 offen offset:2048 nt
    s_nop 4
    v_mov_b32_dpp v36, v20 quad_perm:[0,0,0,0] row_mask:0xf bank_mask:0xf
    v_add_f32_dpp v36, v21, v36 quad_perm:[1,1,1,1] row_mask:0xf bank_mask:0xf
    v_add_f32_dpp v36, v22, v36 quad_perm:[2,2,2,2] row_mask:0xf bank_mask:0xf
    v_add_f32_dpp v36, v23, v36 quad_perm:[3,3,3,3] row_mask:0xf bank_mask:0xf
    v_mov_b32_dpp v37, v24 quad_perm:[0,0,0,0] row_mask:0xf bank_mask:0xf
    v_add_f32_dpp v37, v25, v37 quad_perm:[1,1,1,1] row_mask:0xf bank_mask:0xf
    v_add_f32_dpp v37, v26, v37 quad_perm:[2,2,2,2] row_mask:0xf bank_mask:0xf
    v_add_f32_dpp v37, v27, v37 quad_perm:[3,3,3,3] row_mask:0xf bank_mask:0xf
    v_mov_b32_dpp v38, v48 quad_perm:[0,0,0,0] row_mask:0xf bank_mask:0xf
    v_add_f32_dpp v38, v49, v38 quad_perm:[1,1,1,1] row_mask:0xf bank_mask:0xf
    v_add_f32_dpp v38, v50, v38 quad_perm:[2,2,2,2] row_mask:0xf bank_mask:0xf
    v_add_f32_dpp v38, v51, v38 quad_perm:[3,3,3,3] row_mask:0xf bank_mask:0xf
    v_mov_b32_dpp v39, v52 quad_perm:[0,0,0,0] row_mask:0xf bank_mask:0xf
    v_add_f32_dpp v39, v53, v39 quad_perm:[1,1,1,1] row_mask:0xf bank_mask:0xf
    v_add_f32_dpp v39, v54, v39 quad_perm:[2,2,2,2] row_mask:0xf bank_mask:0xf
    v_add_f32_dpp v39, v55, v39 quad_perm:[3,3,3,3] row_mask:0xf bank_mask:0xf
    v_cvt_pk_bf16_f32 v44, v36, v37
    v_cvt_pk_bf16_f32 v45, v38, v39
    v_lshlrev_b32 v36, 16, v44
    v_and_b32 v37, 0xffff0000, v44
    v_lshlrev_b32 v38, 16, v45
    v_and_b32 v39, 0xffff0000, v45
    v_mul_f32 v36, 0x3db504f3, v36
    v_mul_f32 v37, 0x3db504f3, v37
    v_mul_f32 v38, 0x3db504f3, v38
    v_mul_f32 v39, 0x3db504f3, v39
    v_cvt_pk_bf16_f32 v44, v36, v37
    v_cvt_pk_bf16_f32 v45, v38, v39
    v_lshlrev_b32 v36, 16, v44
    v_and_b32 v37, 0xffff0000, v44
    v_lshlrev_b32 v38, 16, v45
    v_and_b32 v39, 0xffff0000, v45
    v_mul_f32 v36, s8, v36
    v_mul_f32 v37, s8, v37
    v_mul_f32 v38, s8, v38
    v_mul_f32 v39, s8, v39
    v_floor_f32 v20, v36
    v_floor_f32 v21, v37
    v_floor_f32 v22, v38
    v_floor_f32 v23, v39
    v_max3_f32 v44, v20, v21, v22
    v_max3_f32 v44, v44, v23, v32
    v_sub_f32 v40, v36, v20
    v_sub_f32 v41, v37, v21
    v_sub_f32 v42, v38, v22
    v_sub_f32 v43, v39, v23
    v_mov_b32 v45, v44
    s_nop 1
    v_permlane16_swap_b32 v44, v45
    s_nop 1
    v_max_f32 v44, v44, v45
    v_mov_b32 v45, v44
    s_nop 1
    v_permlane32_swap_b32 v44, v45
    s_nop 1
    v_max_f32 v44, v44, v45
    v_exp_f32 v40, v40
    v_exp_f32 v41, v41
    v_exp_f32 v42, v42
    v_exp_f32 v43, v43
    v_sub_f32 v45, v32, v44
    v_cvt_i32_f32 v45, v45
    v_mov_b32 v32, v44
    v_sub_f32 v20, v20, v44
    v_sub_f32 v21, v21, v44
    v_sub_f32 v22, v22, v44
    v_sub_f32 v23, v23, v44
    v_cvt_i32_f32 v20, v20
    v_cvt_i32_f32 v21, v21
    v_cvt_i32_f32 v22, v22
    v_cvt_i32_f32 v23, v23
    s_waitcnt vmcnt(4)
    buffer_load_dwordx4 v[252:255], v10, s[44:47], s9 offen offset:3072 nt
    v_ldexp_f32 v40, v40, v20
    v_ldexp_f32 v41, v41, v21
    v_ldexp_f32 v42, v42, v22
    v_ldexp_f32 v43, v43, v23
    v_ldexp_f32 v28, v28, v45
    v_ldexp_f32 v29, v29, v45
    v_ldexp_f32 v30, v30, v45
    v_ldexp_f32 v31, v31, v45
    v_ldexp_f32 v33, v33, v45
    v_add_f32 v46, v40, v41
    v_add_f32 v47, v42, v43
    v_add_f32 v46, v46, v47
    v_add_f32 v33, v33, v46
    v_cvt_pk_bf16_f32 v34, v40, v40
    v_and_b32 v48, v2, v34
    v_and_b32 v49, v3, v34
    v_and_b32 v50, v4, v34
    v_and_b32 v51, v5, v34
    v_cvt_pk_bf16_f32 v35, v41, v41
    v_and_b32 v52, v2, v35
    v_and_b32 v53, v3, v35
    v_and_b32 v54, v4, v35
    v_and_b32 v55, v5, v35
    v_cvt_pk_bf16_f32 v34, v42, v42
    v_and_b32 v56, v2, v34
    v_and_b32 v57, v3, v34
    v_and_b32 v58, v4, v34
    v_and_b32 v59, v5, v34
    v_cvt_pk_bf16_f32 v35, v43, v43
    v_and_b32 v60, v2, v35
    v_and_b32 v61, v3, v35
    v_and_b32 v62, v4, v35
    v_and_b32 v63, v5, v35
    s_nop 1
    v_mfma_f32_16x16x32_bf16 v[28:31], v[176:179], v[48:51], v[28:31]
    v_mfma_f32_16x16x32_bf16 v[28:31], v[180:183], v[52:55], v[28:31]
    v_mfma_f32_16x16x32_bf16 v[28:31], v[184:187], v[56:59], v[28:31]
    v_mfma_f32_16x16x32_bf16 v[28:31], v[188:191], v[60:63], v[28:31]
L_loop:
    s_waitcnt lgkmcnt(0)
    s_cmp_ge_u32 s11, 4096
    s_cbranch_scc1 L_drain0
    s_mov_b32 s12, s11
    s_lshl_b32 s9, s11, 12
    s_add_u32 s9, s9, s76
    s_add_u32 s10, s10, 1
    s_add_u32 s11, s11, s88
    s_cmp_ge_u32 s12, 3904
    s_cbranch_scc1 L_fmid0
    s_waitcnt vmcnt(8)
    v_mfma_f32_16x16x32_bf16 v[20:23], v[192:195], v[12:15], 0
    v_mfma_f32_16x16x32_bf16 v[24:27], v[196:199], v[12:15], 0
    v_mfma_f32_16x16x32_bf16 v[48:51], v[200:203], v[12:15], 0
    v_mfma_f32_16x16x32_bf16 v[52:55], v[204:207], v[12:15], 0
    s_waitcnt vmcnt(4)
    buffer_load_dwordx4 v[64:67], v9, s[40:43], s9 offen offset:0 nt
    s_nop 4
    v_mov_b32_dpp v36, v20 quad_perm:[0,0,0,0] row_mask:0xf bank_mask:0xf
    v_add_f32_dpp v36, v21, v36 quad_perm:[1,1,1,1] row_mask:0xf bank_mask:0xf
    v_add_f32_dpp v36, v22, v36 quad_perm:[2,2,2,2] row_mask:0xf bank_mask:0xf
    v_add_f32_dpp v36, v23, v36 quad_perm:[3,3,3,3] row_mask:0xf bank_mask:0xf
    v_mov_b32_dpp v37, v24 quad_perm:[0,0,0,0] row_mask:0xf bank_mask:0xf
    v_add_f32_dpp v37, v25, v37 quad_perm:[1,1,1,1] row_mask:0xf bank_mask:0xf
    v_add_f32_dpp v37, v26, v37 quad_perm:[2,2,2,2] row_mask:0xf bank_mask:0xf
    v_add_f32_dpp v37, v27, v37 quad_perm:[3,3,3,3] row_mask:0xf bank_mask:0xf
    s_waitcnt vmcnt(4)
    buffer_load_dwordx4 v[68:71], v9, s[40:43], s9 offen offset:1024 nt
    v_mov_b32_dpp v38, v48 quad_perm:[0,0,0,0] row_mask:0xf bank_mask:0xf
    v_add_f32_dpp v38, v49, v38 quad_perm:[1,1,1,1] row_mask:0xf bank_mask:0xf
    v_add_f32_dpp v38, v50, v38 quad_perm:[2,2,2,2] row_mask:0xf bank_mask:0xf
    v_add_f32_dpp v38, v51, v38 quad_perm:[3,3,3,3] row_mask:0xf bank_mask:0xf
    v_mov_b32_dpp v39, v52 quad_perm:[0,0,0,0] row_mask:0xf bank_mask:0xf
    v_add_f32_dpp v39, v53, v39 quad_perm:[1,1,1,1] row_mask:0xf bank_mask:0xf
    v_add_f32_dpp v39, v54, v39 quad_perm:[2,2,2,2] row_mask:0xf bank_mask:0xf
    v_add_f32_dpp v39, v55, v39 quad_perm:[3,3,3,3] row_mask:0xf bank_mask:0xf
    v_cvt_pk_bf16_f32 v44, v36, v37
    v_cvt_pk_bf16_f32 v45, v38, v39
    v_lshlrev_b32 v36, 16, v44
    v_and_b32 v37, 0xffff0000, v44
    v_lshlrev_b32 v38, 16, v45
    v_and_b32 v39, 0xffff0000, v45
    v_mul_f32 v36, 0x3db504f3, v36
    v_mul_f32 v37, 0x3db504f3, v37
    v_mul_f32 v38, 0x3db504f3, v38
    v_mul_f32 v39, 0x3db504f3, v39
    v_cvt_pk_bf16_f32 v44, v36, v37
    v_cvt_pk_bf16_f32 v45, v38, v39
    v_lshlrev_b32 v36, 16, v44
    v_and_b32 v37, 0xffff0000, v44
    v_lshlrev_b32 v38, 16, v45
    v_and_b32 v39, 0xffff0000, v45
    s_waitcnt vmcnt(4)
    buffer_load_dwordx4 v[72:75], v9, s[40:43], s9 offen offset:2048 nt
    v_mul_f32 v36, s8, v36
    v_mul_f32 v37, s8, v37
    v_mul_f32 v38, s8, v38
    v_mul_f32 v39, s8, v39
    v_floor_f32 v20, v36
    v_floor_f32 v21, v37
    v_floor_f32 v22, v38
    v_floor_f32 v23, v39
    v_max3_f32 v44, v20, v21, v22
    v_max3_f32 v44, v44, v23, v32
    v_sub_f32 v40, v36, v20
    v_sub_f32 v41, v37, v21
    v_sub_f32 v42, v38, v22
    v_sub_f32 v43, v39, v23
    v_mov_b32 v45, v44
    s_nop 1
    v_permlane16_swap_b32 v44, v45
    s_nop 1
    v_max_f32 v44, v44, v45
    v_mov_b32 v45, v44
    s_nop 1
    v_permlane32_swap_b32 v44, v45
    s_nop 1
    v_max_f32 v44, v44, v45
    s_waitcnt vmcnt(4)
    buffer_load_dwordx4 v[76:79], v9, s[40:43], s9 offen offset:3072 nt
    v_exp_f32 v40, v40
    v_exp_f32 v41, v41
    v_exp_f32 v42, v42
    v_exp_f32 v43, v43
    v_sub_f32 v45, v32, v44
    v_cvt_i32_f32 v45, v45
    v_mov_b32 v32, v44
    v_sub_f32 v20, v20, v44
    v_sub_f32 v21, v21, v44
    v_sub_f32 v22, v22, v44
    v_sub_f32 v23, v23, v44
    v_cvt_i32_f32 v20, v20
    v_cvt_i32_f32 v21, v21
    v_cvt_i32_f32 v22, v22
    v_cvt_i32_f32 v23, v23
    s_waitcnt vmcnt(4)
    buffer_load_dwordx4 v[80:83], v10, s[44:47], s9 offen offset:0 nt
    v_ldexp_f32 v40, v40, v20
    v_ldexp_f32 v41, v41, v21
    v_ldexp_f32 v42, v42, v22
    v_ldexp_f32 v43, v43, v23
    v_ldexp_f32 v28, v28, v45
    v_ldexp_f32 v29, v29, v45
    v_ldexp_f32 v30, v30, v45
    v_ldexp_f32 v31, v31, v45
    v_ldexp_f32 v33, v33, v45
    v_add_f32 v46, v40, v41
    v_add_f32 v47, v42, v43
    v_add_f32 v46, v46, v47
    v_add_f32 v33, v33, v46
    s_waitcnt vmcnt(4)
    buffer_load_dwordx4 v[84:87], v10, s[44:47], s9 offen offset:1024 nt
    s_cmp_lt_u32 s10, 58
    s_cbranch_scc1 L_tk1
    s_cmp_lg_u32 s86, 0
    s_mov_b32 s86, 0
    s_cbranch_scc1 L_tk1
    s_cmp_lt_u32 s12, 3776
    s_cselect_b32 s86, 1, 0
    s_add_u32 s11, s86, 1
    s_mov_b32 s88, 1
    s_atomic_add s11, s[74:75], 0 glc
L_tk1:
    v_cvt_pk_bf16_f32 v34, v40, v40
    v_and_b32 v48, v2, v34
    v_and_b32 v49, v3, v34
    v_and_b32 v50, v4, v34
    v_and_b32 v51, v5, v34
    v_cvt_pk_bf16_f32 v35, v41, v41
    v_and_b32 v52, v2, v35
    v_and_b32 v53, v3, v35
    v_and_b32 v54, v4, v35
    v_and_b32 v55, v5, v35
    s_waitcnt vmcnt(4)
    buffer_load_dwordx4 v[88:91], v10, s[44:47], s9 offen offset:2048 nt
    v_cvt_pk_bf16_f32 v34, v42, v42
    v_and_b32 v56, v2, v34
    v_and_b32 v57, v3, v34
    v_and_b32 v58, v4, v34
    v_and_b32 v59, v5, v34
    v_cvt_pk_bf16_f32 v35, v43, v43
    v_and_b32 v60, v2, v35
    v_and_b32 v61, v3, v35
    v_and_b32 v62, v4, v35
    v_and_b32 v63, v5, v35
    s_nop 1
    v_mfma_f32_16x16x32_bf16 v[28:31], v[208:211], v[48:51], v[28:31]
    v_mfma_f32_16x16x32_bf16 v[28:31], v[212:215], v[52:55], v[28:31]
    v_mfma_f32_16x16x32_bf16 v[28:31], v[216:219], v[56:59], v[28:31]
    v_mfma_f32_16x16x32_bf16 v[28:31], v[220:223], v[60:63], v[28:31]
    s_waitcnt vmcnt(4)
    buffer_load_dwordx4 v[92:95], v10, s[44:47], s9 offen offset:3072 nt
    s_waitcnt lgkmcnt(0)
    s_cmp_ge_u32 s11, 4096
    s_cbranch_scc1 L_drain1
    s_mov_b32 s12, s11
    s_lshl_b32 s9, s11, 12
    s_add_u32 s9, s9, s76
    s_add_u32 s10, s10, 1
    s_add_u32 s11, s11, s88
    s_cmp_ge_u32 s12, 3904
    s_cbranch_scc1 L_fmid1
    s_waitcnt vmcnt(8)
    v_mfma_f32_16x16x32_bf16 v[20:23], v[224:227], v[12:15], 0
    v_mfma_f32_16x16x32_bf16 v[24:27], v[228:231], v[12:15], 0
    v_mfma_f32_16x16x32_bf16 v[48:51], v[232:235], v[12:15], 0
    v_mfma_f32_16x16x32_bf16 v[52:55], v[236:239], v[12:15], 0
    s_waitcnt vmcnt(4)
    buffer_load_dwordx4 v[192:195], v9, s[40:43], s9 offen offset:0 nt
    s_nop 4
    v_mov_b32_dpp v36, v20 quad_perm:[0,0,0,0] row_mask:0xf bank_mask:0xf
    v_add_f32_dpp v36, v21, v36 quad_perm:[1,1,1,1] row_mask:0xf bank_mask:0xf
    v_add_f32_dpp v36, v22, v36 quad_perm:[2,2,2,2] row_mask:0xf bank_mask:0xf
    v_add_f32_dpp v36, v23, v36 quad_perm:[3,3,3,3] row_mask:0xf bank_mask:0xf
    v_mov_b32_dpp v37, v24 quad_perm:[0,0,0,0] row_mask:0xf bank_mask:0xf
    v_add_f32_dpp v37, v25, v37 quad_perm:[1,1,1,1] row_mask:0xf bank_mask:0xf
    v_add_f32_dpp v37, v26, v37 quad_perm:[2,2,2,2] row_mask:0xf bank_mask:0xf
    v_add_f32_dpp v37, v27, v37 quad_perm:[3,3,3,3] row_mask:0xf bank_mask:0xf
    s_waitcnt vmcnt(4)
    buffer_load_dwordx4 v[196:199], v9, s[40:43], s9 offen offset:1024 nt
    v_mov_b32_dpp v38, v48 quad_perm:[0,0,0,0] row_mask:0xf bank_mask:0xf
    v_add_f32_dpp v38, v49, v38 quad_perm:[1,1,1,1] row_mask:0xf bank_mask:0xf
    v_add_f32_dpp v38, v50, v38 quad_perm:[2,2,2,2] row_mask:0xf bank_mask:0xf
    v_add_f32_dpp v38, v51, v38 quad_perm:[3,3,3,3] row_mask:0xf bank_mask:0xf
    v_mov_b32_dpp v39, v52 quad_perm:[0,0,0,0] row_mask:0xf bank_mask:0xf
    v_add_f32_dpp v39, v53, v39 quad_perm:[1,1,1,1] row_mask:0xf bank_mask:0xf
    v_add_f32_dpp v39, v54, v39 quad_perm:[2,2,2,2] row_mask:0xf bank_mask:0xf
    v_add_f32_dpp v39, v55, v39 quad_perm:[3,3,3,3] row_mask:0xf bank_mask:0xf
    v_cvt_pk_bf16_f32 v44, v36, v37
    v_cvt_pk_bf16_f32 v45, v38, v39
    v_lshlrev_b32 v36, 16, v44
    v_and_b32 v37, 0xffff0000, v44
    v_lshlrev_b32 v38, 16, v45
    v_and_b32 v39, 0xffff0000, v45
    v_mul_f32 v36, 0x3db504f3, v36
    v_mul_f32 v37, 0x3db504f3, v37
    v_mul_f32 v38, 0x3db504f3, v38
    v_mul_f32 v39, 0x3db504f3, v39
    v_cvt_pk_bf16_f32 v44, v36, v37
    v_cvt_pk_bf16_f32 v45, v38, v39
    v_lshlrev_b32 v36, 16, v44
    v_and_b32 v37, 0xffff0000, v44
    v_lshlrev_b32 v38, 16, v45
    v_and_b32 v39, 0xffff0000, v45
    s_waitcnt vmcnt(4)
    buffer_load_dwordx4 v[200:203], v9, s[40:43], s9 offen offset:2048 nt
    v_mul_f32 v36, s8, v36
    v_mul_f32 v37, s8, v37
    v_mul_f32 v38, s8, v38
    v_mul_f32 v39, s8, v39
    v_floor_f32 v20, v36
    v_floor_f32 v21, v37
    v_floor_f32 v22, v38
    v_floor_f32 v23, v39
    v_max3_f32 v44, v20, v21, v22
    v_max3_f32 v44, v44, v23, v32
    v_sub_f32 v40, v36, v20
    v_sub_f32 v41, v37, v21
    v_sub_f32 v42, v38, v22
    v_sub_f32 v43, v39, v23
    v_mov_b32 v45, v44
    s_nop 1
    v_permlane16_swap_b32 v44, v45
    s_nop 1
    v_max_f32 v44, v44, v45
    v_mov_b32 v45, v44
    s_nop 1
    v_permlane32_swap_b32 v44, v45
    s_nop 1
    v_max_f32 v44, v44, v45
    s_waitcnt vmcnt(4)
    buffer_load_dwordx4 v[204:207], v9, s[40:43], s9 offen offset:3072 nt
    v_exp_f32 v40, v40
    v_exp_f32 v41, v41
    v_exp_f32 v42, v42
    v_exp_f32 v43, v43
    v_sub_f32 v45, v32, v44
    v_cvt_i32_f32 v45, v45
    v_mov_b32 v32, v44
    v_sub_f32 v20, v20, v44
    v_sub_f32 v21, v21, v44
    v_sub_f32 v22, v22, v44
    v_sub_f32 v23, v23, v44
    v_cvt_i32_f32 v20, v20
    v_cvt_i32_f32 v21, v21
    v_cvt_i32_f32 v22, v22
    v_cvt_i32_f32 v23, v23
    s_waitcnt vmcnt(4)
    buffer_load_dwordx4 v[208:211], v10, s[44:47], s9 offen offset:0 nt
    v_ldexp_f32 v40, v40, v20
    v_ldexp_f32 v41, v41, v21
    v_ldexp_f32 v42, v42, v22
    v_ldexp_f32 v43, v43, v23
    v_ldexp_f32 v28, v28, v45
    v_ldexp_f32 v29, v29, v45
    v_ldexp_f32 v30, v30, v45
    v_ldexp_f32 v31, v31, v45
    v_ldexp_f32 v33, v33, v45
    v_add_f32 v46, v40, v41
    v_add_f32 v47, v42, v43
    v_add_f32 v46, v46, v47
    v_add_f32 v33, v33, v46
    s_waitcnt vmcnt(4)
    buffer_load_dwordx4 v[212:215], v10, s[44:47], s9 offen offset:1024 nt
    s_cmp_lt_u32 s10, 58
    s_cbranch_scc1 L_tk2
    s_cmp_lg_u32 s86, 0
    s_mov_b32 s86, 0
    s_cbranch_scc1 L_tk2
    s_cmp_lt_u32 s12, 3776
    s_cselect_b32 s86, 1, 0
    s_add_u32 s11, s86, 1
    s_mov_b32 s88, 1
    s_atomic_add s11, s[74:75], 0 glc
L_tk2:
    v_cvt_pk_bf16_f32 v34, v40, v40
    v_and_b32 v48, v2, v34
    v_and_b32 v49, v3, v34
    v_and_b32 v50, v4, v34
    v_and_b32 v51, v5, v34
    v_cvt_pk_bf16_f32 v35, v41, v41
    v_and_b32 v52, v2, v35
    v_and_b32 v53, v3, v35
    v_and_b32 v54, v4, v35
    v_and_b32 v55, v5, v35
    s_waitcnt vmcnt(4)
    buffer_load_dwordx4 v[216:219], v10, s[44:47], s9 offen offset:2048 nt
    v_cvt_pk_bf16_f32 v34, v42, v42
    v_and_b32 v56, v2, v34
    v_and_b32 v57, v3, v34
    v_and_b32 v58, v4, v34
    v_and_b32 v59, v5, v34
    v_cvt_pk_bf16_f32 v35, v43, v43
    v_and_b32 v60, v2, v35
    v_and_b32 v61, v3, v35
    v_and_b32 v62, v4, v35
    v_and_b32 v63, v5, v35
    s_nop 1
    v_mfma_f32_16x16x32_bf16 v[28:31], v[240:243], v[48:51], v[28:31]
    v_mfma_f32_16x16x32_bf16 v[28:31], v[244:247], v[52:55], v[28:31]
    v_mfma_f32_16x16x32_bf16 v[28:31], v[248:251], v[56:59], v[28:31]
    v_mfma_f32_16x16x32_bf16 v[28:31], v[252:255], v[60:63], v[28:31]
    s_waitcnt vmcnt(4)
    buffer_load_dwordx4 v[220:223], v10, s[44:47], s9 offen offset:3072 nt
    s_waitcnt lgkmcnt(0)
    s_cmp_ge_u32 s11, 4096
    s_cbranch_scc1 L_drain2
    s_mov_b32 s12, s11
    s_lshl_b32 s9, s11, 12
    s_add_u32 s9, s9, s76
    s_add_u32 s10, s10, 1
    s_add_u32 s11, s11, s88
    s_cmp_ge_u32 s12, 3904
    s_cbranch_scc1 L_fmid2
    s_waitcnt vmcnt(8)
    v_mfma_f32_16x16x32_bf16 v[20:23], v[64:67], v[12:15], 0
    v_mfma_f32_16x16x32_bf16 v[24:27], v[68:71], v[12:15], 0
    v_mfma_f32_16x16x32_bf16 v[48:51], v[72:75], v[12:15], 0
    v_mfma_f32_16x16x32_bf16 v[52:55], v[76:79], v[12:15], 0
    s_waitcnt vmcnt(4)
    buffer_load_dwordx4 v[224:227], v9, s[40:43], s9 offen offset:0 nt
    s_nop 4
    v_mov_b32_dpp v36, v20 quad_perm:[0,0,0,0] row_mask:0xf bank_mask:0xf
    v_add_f32_dpp v36, v21, v36 quad_perm:[1,1,1,1] row_mask:0xf bank_mask:0xf
    v_add_f32_dpp v36, v22, v36 quad_perm:[2,2,2,2] row_mask:0xf bank_mask:0xf
    v_add_f32_dpp v36, v23, v36 quad_perm:[3,3,3,3] row_mask:0xf bank_mask:0xf
    v_mov_b32_dpp v37, v24 quad_perm:[0,0,0,0] row_mask:0xf bank_mask:0xf
    v_add_f32_dpp v37, v25, v37 quad_perm:[1,1,1,1] row_mask:0xf bank_mask:0xf
    v_add_f32_dpp v37, v26, v37 quad_perm:[2,2,2,2] row_mask:0xf bank_mask:0xf
    v_add_f32_dpp v37, v27, v37 quad_perm:[3,3,3,3] row_mask:0xf bank_mask:0xf
    s_waitcnt vmcnt(4)
    buffer_load_dwordx4 v[228:231], v9, s[40:43], s9 offen offset:1024 nt
    v_mov_b32_dpp v38, v48 quad_perm:[0,0,0,0] row_mask:0xf bank_mask:0xf
    v_add_f32_dpp v38, v49, v38 quad_perm:[1,1,1,1] row_mask:0xf bank_mask:0xf
    v_add_f32_dpp v38, v50, v38 quad_perm:[2,2,2,2] row_mask:0xf bank_mask:0xf
    v_add_f32_dpp v38, v51, v38 quad_perm:[3,3,3,3] row_mask:0xf bank_mask:0xf
    v_mov_b32_dpp v39, v52 quad_perm:[0,0,0,0] row_mask:0xf bank_mask:0xf
    v_add_f32_dpp v39, v53, v39 quad_perm:[1,1,1,1] row_mask:0xf bank_mask:0xf
    v_add_f32_dpp v39, v54, v39 quad_perm:[2,2,2,2] row_mask:0xf bank_mask:0xf
    v_add_f32_dpp v39, v55, v39 quad_perm:[3,3,3,3] row_mask:0xf bank_mask:0xf
    v_cvt_pk_bf16_f32 v44, v36, v37
    v_cvt_pk_bf16_f32 v45, v38, v39
    v_lshlrev_b32 v36, 16, v44
    v_and_b32 v37, 0xffff0000, v44
    v_lshlrev_b32 v38, 16, v45
    v_and_b32 v39, 0xffff0000, v45
    v_mul_f32 v36, 0x3db504f3, v36
    v_mul_f32 v37, 0x3db504f3, v37
    v_mul_f32 v38, 0x3db504f3, v38
    v_mul_f32 v39, 0x3db504f3, v39
    v_cvt_pk_bf16_f32 v44, v36, v37
    v_cvt_pk_bf16_f32 v45, v38, v39
    v_lshlrev_b32 v36, 16, v44
    v_and_b32 v37, 0xffff0000, v44
    v_lshlrev_b32 v38, 16, v45
    v_and_b32 v39, 0xffff0000, v45
    s_waitcnt vmcnt(4)
    buffer_load_dwordx4 v[232:235], v9, s[40:43], s9 offen offset:2048 nt
    v_mul_f32 v36, s8, v36
    v_mul_f32 v37, s8, v37
    v_mul_f32 v38, s8, v38
    v_mul_f32 v39, s8, v39
    v_floor_f32 v20, v36
    v_floor_f32 v21, v37
    v_floor_f32 v22, v38
    v_floor_f32 v23, v39
    v_max3_f32 v44, v20, v21, v22
    v_max3_f32 v44, v44, v23, v32
    v_sub_f32 v40, v36, v20
    v_sub_f32 v41, v37, v21
    v_sub_f32 v42, v38, v22
    v_sub_f32 v43, v39, v23
    v_mov_b32 v45, v44
    s_nop 1
    v_permlane16_swap_b32 v44, v45
    s_nop 1
    v_max_f32 v44, v44, v45
    v_mov_b32 v45, v44
    s_nop 1
    v_permlane32_swap_b32 v44, v45
    s_nop 1
    v_max_f32 v44, v44, v45
    s_waitcnt vmcnt(4)
    buffer_load_dwordx4 v[236:239], v9, s[40:43], s9 offen offset:3072 nt
    v_exp_f32 v40, v40
    v_exp_f32 v41, v41
    v_exp_f32 v42, v42
    v_exp_f32 v43, v43
    v_sub_f32 v45, v32, v44
    v_cvt_i32_f32 v45, v45
    v_mov_b32 v32, v44
    v_sub_f32 v20, v20, v44
    v_sub_f32 v21, v21, v44
    v_sub_f32 v22, v22, v44
    v_sub_f32 v23, v23, v44
    v_cvt_i32_f32 v20, v20
    v_cvt_i32_f32 v21, v21
    v_cvt_i32_f32 v22, v22
    v_cvt_i32_f32 v23, v23
    s_waitcnt vmcnt(4)
    buffer_load_dwordx4 v[240:243], v10, s[44:47], s9 offen offset:0 nt
    v_ldexp_f32 v40, v40, v20
    v_ldexp_f32 v41, v41, v21
    v_ldexp_f32 v42, v42, v22
    v_ldexp_f32 v43, v43, v23
    v_ldexp_f32 v28, v28, v45
    v_ldexp_f32 v29, v29, v45
    v_ldexp_f32 v30, v30, v45
    v_ldexp_f32 v31, v31, v45
    v_ldexp_f32 v33, v33, v45
    v_add_f32 v46, v40, v41
    v_add_f32 v47, v42, v43
    v_add_f32 v46, v46, v47
    v_add_f32 v33, v33, v46
    s_waitcnt vmcnt(4)
    buffer_load_dwordx4 v[244:247], v10, s[44:47], s9 offen offset:1024 nt
    s_cmp_lt_u32 s10, 58
    s_cbranch_scc1 L_tk3
    s_cmp_lg_u32 s86, 0
    s_mov_b32 s86, 0
    s_cbranch_scc1 L_tk3
    s_cmp_lt_u32 s12, 3776
    s_cselect_b32 s86, 1, 0
    s_add_u32 s11, s86, 1
    s_mov_b32 s88, 1
    s_atomic_add s11, s[74:75], 0 glc
L_tk3:
    v_cvt_pk_bf16_f32 v34, v40, v40
    v_and_b32 v48, v2, v34
    v_and_b32 v49, v3, v34
    v_and_b32 v50, v4, v34
    v_and_b32 v51, v5, v34
    v_cvt_pk_bf16_f32 v35, v41, v41
    v_and_b32 v52, v2, v35
    v_and_b32 v53, v3, v35
    v_and_b32 v54, v4, v35
    v_and_b32 v55, v5, v35
    s_waitcnt vmcnt(4)
    buffer_load_dwordx4 v[248:251], v10, s[44:47], s9 offen offset:2048 nt
    v_cvt_pk_bf16_f32 v34, v42, v42
    v_and_b32 v56, v2, v34
    v_and_b32 v57, v3, v34
    v_and_b32 v58, v4, v34
    v_and_b32 v59, v5, v34
    v_cvt_pk_bf16_f32 v35, v43, v43
    v_and_b32 v60, v2, v35
    v_and_b32 v61, v3, v35
    v_and_b32 v62, v4, v35
    v_and_b32 v63, v5, v35
    s_nop 1
    v_mfma_f32_16x16x32_bf16 v[28:31], v[80:83], v[48:51], v[28:31]
    v_mfma_f32_16x16x32_bf16 v[28:31], v[84:87], v[52:55], v[28:31]
    v_mfma_f32_16x16x32_bf16 v[28:31], v[88:91], v[56:59], v[28:31]
    v_mfma_f32_16x16x32_bf16 v[28:31], v[92:95], v[60:63], v[28:31]
    s_waitcnt vmcnt(4)
    buffer_load_dwordx4 v[252:255], v10, s[44:47], s9 offen offset:3072 nt
    s_branch L_loop
L_floop:
    s_waitcnt lgkmcnt(0)
    s_cmp_ge_u32 s11, 4096
    s_cbranch_scc1 L_drain0
    s_mov_b32 s12, s11
    s_lshl_b32 s9, s11, 12
    s_add_u32 s9, s9, s76
    s_add_u32 s10, s10, 1
    s_add_u32 s11, s11, s88
L_fmid0:
    s_waitcnt vmcnt(8)
    v_mfma_f32_16x16x32_bf16 v[20:23], v[192:195], v[12:15], 0
    v_mfma_f32_16x16x32_bf16 v[24:27], v[196:199], v[12:15], 0
    v_mfma_f32_16x16x32_bf16 v[48:51], v[200:203], v[12:15], 0
    v_mfma_f32_16x16x32_bf16 v[52:55], v[204:207], v[12:15], 0
    s_waitcnt vmcnt(9)
    buffer_load_dwordx4 v[64:67], v9, s[40:43], s9 offen offset:0 nt
    s_nop 4
    v_mov_b32_dpp v36, v20 quad_perm:[0,0,0,0] row_mask:0xf bank_mask:0xf
    v_add_f32_dpp v36, v21, v36 quad_perm:[1,1,1,1] row_mask:0xf bank_mask:0xf
    v_add_f32_dpp v36, v22, v36 quad_perm:[2,2,2,2] row_mask:0xf bank_mask:0xf
    v_add_f32_dpp v36, v23, v36 quad_perm:[3,3,3,3] row_mask:0xf bank_mask:0xf
    v_mov_b32_dpp v37, v24 quad_perm:[0,0,0,0] row_mask:0xf bank_mask:0xf
    v_add_f32_dpp v37, v25, v37 quad_perm:[1,1,1,1] row_mask:0xf bank_mask:0xf
    v_add_f32_dpp v37, v26, v37 quad_perm:[2,2,2,2] row_mask:0xf bank_mask:0xf
    v_add_f32_dpp v37, v27, v37 quad_perm:[3,3,3,3] row_mask:0xf bank_mask:0xf
    s_waitcnt vmcnt(9)
    buffer_load_dwordx4 v[68:71], v9, s[40:43], s9 offen offset:1024 nt
    s_cmp_lt_u32 s10, 58
    s_cbranch_scc1 L_tk4
    s_cmp_lg_u32 s86, 0
    s_mov_b32 s86, 0
    s_cbranch_scc1 L_tk4
    s_cmp_lt_u32 s12, 3776
    s_cselect_b32 s86, 1, 0
    s_add_u32 s11, s86, 1
    s_mov_b32 s88, 1
    s_atomic_add s11, s[74:75], 0 glc
L_tk4:
    v_mov_b32_dpp v38, v48 quad_perm:[0,0,0,0] row_mask:0xf bank_mask:0xf
    v_add_f32_dpp v38, v49, v38 quad_perm:[1,1,1,1] row_mask:0xf bank_mask:0xf
    v_add_f32_dpp v38, v50, v38 quad_perm:[2,2,2,2] row_mask:0xf bank_mask:0xf
    v_add_f32_dpp v38, v51, v38 quad_perm:[3,3,3,3] row_mask:0xf bank_mask:0xf
    v_mov_b32_dpp v39, v52 quad_perm:[0,0,0,0] row_mask:0xf bank_mask:0xf
    v_add_f32_dpp v39, v53, v39 quad_perm:[1,1,1,1] row_mask:0xf bank_mask:0xf
    v_add_f32_dpp v39, v54, v39 quad_perm:[2,2,2,2] row_mask:0xf bank_mask:0xf
    v_add_f32_dpp v39, v55, v39 quad_perm:[3,3,3,3] row_mask:0xf bank_mask:0xf
    v_cvt_pk_bf16_f32 v44, v36, v37
    v_cvt_pk_bf16_f32 v45, v38, v39
    v_lshlrev_b32 v36, 16, v44
    v_and_b32 v37, 0xffff0000, v44
    v_lshlrev_b32 v38, 16, v45
    v_and_b32 v39, 0xffff0000, v45
    v_mul_f32 v36, 0x3db504f3, v36
    v_mul_f32 v37, 0x3db504f3, v37
    v_mul_f32 v38, 0x3db504f3, v38
    v_mul_f32 v39, 0x3db504f3, v39
    v_cvt_pk_bf16_f32 v44, v36, v37
    v_cvt_pk_bf16_f32 v45, v38, v39
    v_lshlrev_b32 v36, 16, v44
    v_and_b32 v37, 0xffff0000, v44
    v_lshlrev_b32 v38, 16, v45
    v_and_b32 v39, 0xffff0000, v45
    s_waitcnt vmcnt(9)
    buffer_load_dwordx4 v[72:75], v9, s[40:43], s9 offen offset:2048 nt
    v_mul_f32 v36, s8, v36
    v_mul_f32 v37, s8, v37
    v_mul_f32 v38, s8, v38
    v_mul_f32 v39, s8, v39
    v_floor_f32 v20, v36
    v_floor_f32 v21, v37
    v_floor_f32 v22, v38
    v_floor_f32 v23, v39
    v_max3_f32 v44, v20, v21, v22
    v_max3_f32 v44, v44, v23, v32
    v_sub_f32 v40, v36, v20
    v_sub_f32 v41, v37, v21
    v_sub_f32 v42, v38, v22
    v_sub_f32 v43, v39, v23
    v_mov_b32 v45, v44
    s_nop 1
    v_permlane16_swap_b32 v44, v45
    s_nop 1
    v_max_f32 v44, v44, v45
    v_mov_b32 v45, v44
    s_nop 1
    v_permlane32_swap_b32 v44, v45
    s_nop 1
    v_max_f32 v44, v44, v45
    s_waitcnt vmcnt(9)
    buffer_load_dwordx4 v[76:79], v9, s[40:43], s9 offen offset:3072 nt
    v_exp_f32 v40, v40
    v_exp_f32 v41, v41
    v_exp_f32 v42, v42
    v_exp_f32 v43, v43
    v_sub_f32 v45, v32, v44
    v_cvt_i32_f32 v45, v45
    v_mov_b32 v32, v44
    v_sub_f32 v20, v20, v44
    v_sub_f32 v21, v21, v44
    v_sub_f32 v22, v22, v44
    v_sub_f32 v23, v23, v44
    v_cvt_i32_f32 v20, v20
    v_cvt_i32_f32 v21, v21
    v_cvt_i32_f32 v22, v22
    v_cvt_i32_f32 v23, v23
    s_waitcnt vmcnt(9)
    buffer_load_dwordx4 v[80:83], v10, s[44:47], s9 offen offset:0 nt
    v_ldexp_f32 v40, v40, v20
    v_ldexp_f32 v41, v41, v21
    v_ldexp_f32 v42, v42, v22
    v_ldexp_f32 v43, v43, v23
    v_ldexp_f32 v28, v28, v45
    v_ldexp_f32 v29, v29, v45
    v_ldexp_f32 v30, v30, v45
    v_ldexp_f32 v31, v31, v45
    v_ldexp_f32 v33, v33, v45
    v_add_f32 v46, v40, v41
    v_add_f32 v47, v42, v43
    v_add_f32 v46, v46, v47
    v_add_f32 v33, v33, v46
    s_waitcnt vmcnt(9)
    buffer_load_dwordx4 v[84:87], v10, s[44:47], s9 offen offset:1024 nt
    v_cvt_pk_bf16_f32 v34, v40, v40
    v_and_b32 v48, v2, v34
    v_and_b32 v49, v3, v34
    v_and_b32 v50, v4, v34
    v_and_b32 v51, v5, v34
    v_cvt_pk_bf16_f32 v35, v41, v41
    v_and_b32 v52, v2, v35
    v_and_b32 v53, v3, v35
    v_and_b32 v54, v4, v35
    v_and_b32 v55, v5, v35
    s_waitcnt vmcnt(9)
    buffer_load_dwordx4 v[88:91], v10, s[44:47], s9 offen offset:2048 nt
    v_cvt_pk_bf16_f32 v34, v42, v42
    v_and_b32 v56, v2, v34
    v_and_b32 v57, v3, v34
    v_and_b32 v58, v4, v34
    v_and_b32 v59, v5, v34
    v_cvt_pk_bf16_f32 v35, v43, v43
    v_and_b32 v60, v2, v35
    v_and_b32 v61, v3, v35
    v_and_b32 v62, v4, v35
    v_and_b32 v63, v5, v35
    s_nop 1
    v_mfma_f32_16x16x32_bf16 v[28:31], v[208:211], v[48:51], v[28:31]
    v_mfma_f32_16x16x32_bf16 v[28:31], v[212:215], v[52:55], v[28:31]
    v_mfma_f32_16x16x32_bf16 v[28:31], v[216:219], v[56:59], v[28:31]
    v_mfma_f32_16x16x32_bf16 v[28:31], v[220:223], v[60:63], v[28:31]
    s_waitcnt vmcnt(9)
    buffer_load_dwordx4 v[92:95], v10, s[44:47], s9 offen offset:3072 nt
    s_waitcnt lgkmcnt(0)
    s_cmp_ge_u32 s11, 4096
    s_cbranch_scc1 L_drain1
    s_mov_b32 s12, s11
    s_lshl_b32 s9, s11, 12
    s_add_u32 s9, s9, s76
    s_add_u32 s10, s10, 1
    s_add_u32 s11, s11, s88
L_fmid1:
    s_waitcnt vmcnt(8)
    v_mfma_f32_16x16x32_bf16 v[20:23], v[224:227], v[12:15], 0
    v_mfma_f32_16x16x32_bf16 v[24:27], v[228:231], v[12:15], 0
    v_mfma_f32_16x16x32_bf16 v[48:51], v[232:235], v[12:15], 0
    v_mfma_f32_16x16x32_bf16 v[52:55], v[236:239], v[12:15], 0
    s_waitcnt vmcnt(9)
    buffer_load_dwordx4 v[192:195], v9, s[40:43], s9 offen offset:0 nt
    s_nop 4
    v_mov_b32_dpp v36, v20 quad_perm:[0,0,0,0] row_mask:0xf bank_mask:0xf
    v_add_f32_dpp v36, v21, v36 quad_perm:[1,1,1,1] row_mask:0xf bank_mask:0xf
    v_add_f32_dpp v36, v22, v36 quad_perm:[2,2,2,2] row_mask:0xf bank_mask:0xf
    v_add_f32_dpp v36, v23, v36 quad_perm:[3,3,3,3] row_mask:0xf bank_mask:0xf
    v_mov_b32_dpp v37, v24 quad_perm:[0,0,0,0] row_mask:0xf bank_mask:0xf
    v_add_f32_dpp v37, v25, v37 quad_perm:[1,1,1,1] row_mask:0xf bank_mask:0xf
    v_add_f32_dpp v37, v26, v37 quad_perm:[2,2,2,2] row_mask:0xf bank_mask:0xf
    v_add_f32_dpp v37, v27, v37 quad_perm:[3,3,3,3] row_mask:0xf bank_mask:0xf
    s_waitcnt vmcnt(9)
    buffer_load_dwordx4 v[196:199], v9, s[40:43], s9 offen offset:1024 nt
    s_cmp_lt_u32 s10, 58
    s_cbranch_scc1 L_tk5
    s_cmp_lg_u32 s86, 0
    s_mov_b32 s86, 0
    s_cbranch_scc1 L_tk5
    s_cmp_lt_u32 s12, 3776
    s_cselect_b32 s86, 1, 0
    s_add_u32 s11, s86, 1
    s_mov_b32 s88, 1
    s_atomic_add s11, s[74:75], 0 glc
L_tk5:
    v_mov_b32_dpp v38, v48 quad_perm:[0,0,0,0] row_mask:0xf bank_mask:0xf
    v_add_f32_dpp v38, v49, v38 quad_perm:[1,1,1,1] row_mask:0xf bank_mask:0xf
    v_add_f32_dpp v38, v50, v38 quad_perm:[2,2,2,2] row_mask:0xf bank_mask:0xf
    v_add_f32_dpp v38, v51, v38 quad_perm:[3,3,3,3] row_mask:0xf bank_mask:0xf
    v_mov_b32_dpp v39, v52 quad_perm:[0,0,0,0] row_mask:0xf bank_mask:0xf
    v_add_f32_dpp v39, v53, v39 quad_perm:[1,1,1,1] row_mask:0xf bank_mask:0xf
    v_add_f32_dpp v39, v54, v39 quad_perm:[2,2,2,2] row_mask:0xf bank_mask:0xf
    v_add_f32_dpp v39, v55, v39 quad_perm:[3,3,3,3] row_mask:0xf bank_mask:0xf
    v_cvt_pk_bf16_f32 v44, v36, v37
    v_cvt_pk_bf16_f32 v45, v38, v39
    v_lshlrev_b32 v36, 16, v44
    v_and_b32 v37, 0xffff0000, v44
    v_lshlrev_b32 v38, 16, v45
    v_and_b32 v39, 0xffff0000, v45
    v_mul_f32 v36, 0x3db504f3, v36
    v_mul_f32 v37, 0x3db504f3, v37
    v_mul_f32 v38, 0x3db504f3, v38
    v_mul_f32 v39, 0x3db504f3, v39
    v_cvt_pk_bf16_f32 v44, v36, v37
    v_cvt_pk_bf16_f32 v45, v38, v39
    v_lshlrev_b32 v36, 16, v44
    v_and_b32 v37, 0xffff0000, v44
    v_lshlrev_b32 v38, 16, v45
    v_and_b32 v39, 0xffff0000, v45
    s_waitcnt vmcnt(9)
    buffer_load_dwordx4 v[200:203], v9, s[40:43], s9 offen offset:2048 nt
    v_mul_f32 v36, s8, v36
    v_mul_f32 v37, s8, v37
    v_mul_f32 v38, s8, v38
    v_mul_f32 v39, s8, v39
    v_floor_f32 v20, v36
    v_floor_f32 v21, v37
    v_floor_f32 v22, v38
    v_floor_f32 v23, v39
    v_max3_f32 v44, v20, v21, v22
    v_max3_f32 v44, v44, v23, v32
    v_sub_f32 v40, v36, v20
    v_sub_f32 v41, v37, v21
    v_sub_f32 v42, v38, v22
    v_sub_f32 v43, v39, v23
    v_mov_b32 v45, v44
    s_nop 1
    v_permlane16_swap_b32 v44, v45
    s_nop 1
    v_max_f32 v44, v44, v45
    v_mov_b32 v45, v44
    s_nop 1
    v_permlane32_swap_b32 v44, v45
    s_nop 1
    v_max_f32 v44, v44, v45
    s_waitcnt vmcnt(9)
    buffer_load_dwordx4 v[204:207], v9, s[40:43], s9 offen offset:3072 nt
    v_exp_f32 v40, v40
    v_exp_f32 v41, v41
    v_exp_f32 v42, v42
    v_exp_f32 v43, v43
    v_sub_f32 v45, v32, v44
    v_cvt_i32_f32 v45, v45
    v_mov_b32 v32, v44
    v_sub_f32 v20, v20, v44
    v_sub_f32 v21, v21, v44
    v_sub_f32 v22, v22, v44
    v_sub_f32 v23, v23, v44
    v_cvt_i32_f32 v20, v20
    v_cvt_i32_f32 v21, v21
    v_cvt_i32_f32 v22, v22
    v_cvt_i32_f32 v23, v23
    s_waitcnt vmcnt(9)
    buffer_load_dwordx4 v[208:211], v10, s[44:47], s9 offen offset:0 nt
    v_ldexp_f32 v40, v40, v20
    v_ldexp_f32 v41, v41, v21
    v_ldexp_f32 v42, v42, v22
    v_ldexp_f32 v43, v43, v23
    v_ldexp_f32 v28, v28, v45
    v_ldexp_f32 v29, v29, v45
    v_ldexp_f32 v30, v30, v45
    v_ldexp_f32 v31, v31, v45
    v_ldexp_f32 v33, v33, v45
    v_add_f32 v46, v40, v41
    v_add_f32 v47, v42, v43
    v_add_f32 v46, v46, v47
    v_add_f32 v33, v33, v46
    s_waitcnt vmcnt(9)
    buffer_load_dwordx4 v[212:215], v10, s[44:47], s9 offen offset:1024 nt
    v_cvt_pk_bf16_f32 v34, v40, v40
    v_and_b32 v48, v2, v34
    v_and_b32 v49, v3, v34
    v_and_b32 v50, v4, v34
    v_and_b32 v51, v5, v34
    v_cvt_pk_bf16_f32 v35, v41, v41
    v_and_b32 v52, v2, v35
    v_and_b32 v53, v3, v35
    v_and_b32 v54, v4, v35
    v_and_b32 v55, v5, v35
    s_waitcnt vmcnt(9)
    buffer_load_dwordx4 v[216:219], v10, s[44:47], s9 offen offset:2048 nt
    v_cvt_pk_bf16_f32 v34, v42, v42
    v_and_b32 v56, v2, v34
    v_and_b32 v57, v3, v34
    v_and_b32 v58, v4, v34
    v_and_b32 v59, v5, v34
    v_cvt_pk_bf16_f32 v35, v43, v43
    v_and_b32 v60, v2, v35
    v_and_b32 v61, v3, v35
    v_and_b32 v62, v4, v35
    v_and_b32 v63, v5, v35
    s_nop 1
    v_mfma_f32_16x16x32_bf16 v[28:31], v[240:243], v[48:51], v[28:31]
    v_mfma_f32_16x16x32_bf16 v[28:31], v[244:247], v[52:55], v[28:31]
    v_mfma_f32_16x16x32_bf16 v[28:31], v[248:251], v[56:59], v[28:31]
    v_mfma_f32_16x16x32_bf16 v[28:31], v[252:255], v[60:63], v[28:31]
    s_waitcnt vmcnt(9)
    buffer_load_dwordx4 v[220:223], v10, s[44:47], s9 offen offset:3072 nt
    s_waitcnt lgkmcnt(0)
    s_cmp_ge_u32 s11, 4096
    s_cbranch_scc1 L_drain2
    s_mov_b32 s12, s11
    s_lshl_b32 s9, s11, 12
    s_add_u32 s9, s9, s76
    s_add_u32 s10, s10, 1
    s_add_u32 s11, s11, s88
L_fmid2:
    s_waitcnt vmcnt(8)
    v_mfma_f32_16x16x32_bf16 v[20:23], v[64:67], v[12:15], 0
    v_mfma_f32_16x16x32_bf16 v[24:27], v[68:71], v[12:15], 0
    v_mfma_f32_16x16x32_bf16 v[48:51], v[72:75], v[12:15], 0
    v_mfma_f32_16x16x32_bf16 v[52:55], v[76:79], v[12:15], 0
    s_waitcnt vmcnt(9)
    buffer_load_dwordx4 v[224:227], v9, s[40:43], s9 offen offset:0 nt
    s_nop 4
    v_mov_b32_dpp v36, v20 quad_perm:[0,0,0,0] row_mask:0xf bank_mask:0xf
    v_add_f32_dpp v36, v21, v36 quad_perm:[1,1,1,1] row_mask:0xf bank_mask:0xf
    v_add_f32_dpp v36, v22, v36 quad_perm:[2,2,2,2] row_mask:0xf bank_mask:0xf
    v_add_f32_dpp v36, v23, v36 quad_perm:[3,3,3,3] row_mask:0xf bank_mask:0xf
    v_mov_b32_dpp v37, v24 quad_perm:[0,0,0,0] row_mask:0xf bank_mask:0xf
    v_add_f32_dpp v37, v25, v37 quad_perm:[1,1,1,1] row_mask:0xf bank_mask:0xf
    v_add_f32_dpp v37, v26, v37 quad_perm:[2,2,2,2] row_mask:0xf bank_mask:0xf
    v_add_f32_dpp v37, v27, v37 quad_perm:[3,3,3,3] row_mask:0xf bank_mask:0xf
    s_waitcnt vmcnt(9)
    buffer_load_dwordx4 v[228:231], v9, s[40:43], s9 offen offset:1024 nt
    s_cmp_lt_u32 s10, 58
    s_cbranch_scc1 L_tk6
    s_cmp_lg_u32 s86, 0
    s_mov_b32 s86, 0
    s_cbranch_scc1 L_tk6
    s_cmp_lt_u32 s12, 3776
    s_cselect_b32 s86, 1, 0
    s_add_u32 s11, s86, 1
    s_mov_b32 s88, 1
    s_atomic_add s11, s[74:75], 0 glc
L_tk6:
    v_mov_b32_dpp v38, v48 quad_perm:[0,0,0,0] row_mask:0xf bank_mask:0xf
    v_add_f32_dpp v38, v49, v38 quad_perm:[1,1,1,1] row_mask:0xf bank_mask:0xf
    v_add_f32_dpp v38, v50, v38 quad_perm:[2,2,2,2] row_mask:0xf bank_mask:0xf
    v_add_f32_dpp v38, v51, v38 quad_perm:[3,3,3,3] row_mask:0xf bank_mask:0xf
    v_mov_b32_dpp v39, v52 quad_perm:[0,0,0,0] row_mask:0xf bank_mask:0xf
    v_add_f32_dpp v39, v53, v39 quad_perm:[1,1,1,1] row_mask:0xf bank_mask:0xf
    v_add_f32_dpp v39, v54, v39 quad_perm:[2,2,2,2] row_mask:0xf bank_mask:0xf
    v_add_f32_dpp v39, v55, v39 quad_perm:[3,3,3,3] row_mask:0xf bank_mask:0xf
    v_cvt_pk_bf16_f32 v44, v36, v37
    v_cvt_pk_bf16_f32 v45, v38, v39
    v_lshlrev_b32 v36, 16, v44
    v_and_b32 v37, 0xffff0000, v44
    v_lshlrev_b32 v38, 16, v45
    v_and_b32 v39, 0xffff0000, v45
    v_mul_f32 v36, 0x3db504f3, v36
    v_mul_f32 v37, 0x3db504f3, v37
    v_mul_f32 v38, 0x3db504f3, v38
    v_mul_f32 v39, 0x3db504f3, v39
    v_cvt_pk_bf16_f32 v44, v36, v37
    v_cvt_pk_bf16_f32 v45, v38, v39
    v_lshlrev_b32 v36, 16, v44
    v_and_b32 v37, 0xffff0000, v44
    v_lshlrev_b32 v38, 16, v45
    v_and_b32 v39, 0xffff0000, v45
    s_waitcnt vmcnt(9)
    buffer_load_dwordx4 v[232:235], v9, s[40:43], s9 offen offset:2048 nt
    v_mul_f32 v36, s8, v36
    v_mul_f32 v37, s8, v37
    v_mul_f32 v38, s8, v38
    v_mul_f32 v39, s8, v39
    v_floor_f32 v20, v36
    v_floor_f32 v21, v37
    v_floor_f32 v22, v38
    v_floor_f32 v23, v39
    v_max3_f32 v44, v20, v21, v22
    v_max3_f32 v44, v44, v23, v32
    v_sub_f32 v40, v36, v20
    v_sub_f32 v41, v37, v21
    v_sub_f32 v42, v38, v22
    v_sub_f32 v43, v39, v23
    v_mov_b32 v45, v44
    s_nop 1
    v_permlane16_swap_b32 v44, v45
    s_nop 1
    v_max_f32 v44, v44, v45
    v_mov_b32 v45, v44
    s_nop 1
    v_permlane32_swap_b32 v44, v45
    s_nop 1
    v_max_f32 v44, v44, v45
    s_waitcnt vmcnt(9)
    buffer_load_dwordx4 v[236:239], v9, s[40:43], s9 offen offset:3072 nt
    v_exp_f32 v40, v40
    v_exp_f32 v41, v41
    v_exp_f32 v42, v42
    v_exp_f32 v43, v43
    v_sub_f32 v45, v32, v44
    v_cvt_i32_f32 v45, v45
    v_mov_b32 v32, v44
    v_sub_f32 v20, v20, v44
    v_sub_f32 v21, v21, v44
    v_sub_f32 v22, v22, v44
    v_sub_f32 v23, v23, v44
    v_cvt_i32_f32 v20, v20
    v_cvt_i32_f32 v21, v21
    v_cvt_i32_f32 v22, v22
    v_cvt_i32_f32 v23, v23
    s_waitcnt vmcnt(9)
    buffer_load_dwordx4 v[240:243], v10, s[44:47], s9 offen offset:0 nt
    v_ldexp_f32 v40, v40, v20
    v_ldexp_f32 v41, v41, v21
    v_ldexp_f32 v42, v42, v22
    v_ldexp_f32 v43, v43, v23
    v_ldexp_f32 v28, v28, v45
    v_ldexp_f32 v29, v29, v45
    v_ldexp_f32 v30, v30, v45
    v_ldexp_f32 v31, v31, v45
    v_ldexp_f32 v33, v33, v45
    v_add_f32 v46, v40, v41
    v_add_f32 v47, v42, v43
    v_add_f32 v46, v46, v47
    v_add_f32 v33, v33, v46
    s_waitcnt vmcnt(9)
    buffer_load_dwordx4 v[244:247], v10, s[44:47], s9 offen offset:1024 nt
    v_cvt_pk_bf16_f32 v34, v40, v40
    v_and_b32 v48, v2, v34
    v_and_b32 v49, v3, v34
    v_and_b32 v50, v4, v34
    v_and_b32 v51, v5, v34
    v_cvt_pk_bf16_f32 v35, v41, v41
    v_and_b32 v52, v2, v35
    v_and_b32 v53, v3, v35
    v_and_b32 v54, v4, v35
    v_and_b32 v55, v5, v35
    s_waitcnt vmcnt(9)
    buffer_load_dwordx4 v[248:251], v10, s[44:47], s9 offen offset:2048 nt
    v_cvt_pk_bf16_f32 v34, v42, v42
    v_and_b32 v56, v2, v34
    v_and_b32 v57, v3, v34
    v_and_b32 v58, v4, v34
    v_and_b32 v59, v5, v34
    v_cvt_pk_bf16_f32 v35, v43, v43
    v_and_b32 v60, v2, v35
    v_and_b32 v61, v3, v35
    v_and_b32 v62, v4, v35
    v_and_b32 v63, v5, v35
    s_nop 1
    v_mfma_f32_16x16x32_bf16 v[28:31], v[80:83], v[48:51], v[28:31]
    v_mfma_f32_16x16x32_bf16 v[28:31], v[84:87], v[52:55], v[28:31]
    v_mfma_f32_16x16x32_bf16 v[28:31], v[88:91], v[56:59], v[28:31]
    v_mfma_f32_16x16x32_bf16 v[28:31], v[92:95], v[60:63], v[28:31]
    s_waitcnt vmcnt(9)
    buffer_load_dwordx4 v[252:255], v10, s[44:47], s9 offen offset:3072 nt
    s_branch L_floop
L_drain0:
    buffer_load_dwordx4 v[96:99], v8, s[48:51], s81 offen offset:0 nt
    buffer_load_dwordx4 v[100:103], v8, s[48:51], s81 offen offset:1152 nt
    buffer_load_dwordx4 v[104:107], v8, s[48:51], s81 offen offset:2304 nt
    buffer_load_dwordx4 v[108:111], v8, s[48:51], s81 offen offset:3456 nt
    buffer_load_dwordx4 v[112:115], v8, s[48:51], s82 offen offset:0 nt
    buffer_load_dwordx4 v[116:119], v8, s[48:51], s82 offen offset:1152 nt
    buffer_load_dwordx4 v[120:123], v8, s[48:51], s82 offen offset:2304 nt
    buffer_load_dwordx4 v[124:127], v8, s[48:51], s82 offen offset:3456 nt
    s_waitcnt vmcnt(16)
    v_mfma_f32_16x16x32_bf16 v[20:23], v[192:195], v[12:15], 0
    v_mfma_f32_16x16x32_bf16 v[24:27], v[196:199], v[12:15], 0
    v_mfma_f32_16x16x32_bf16 v[48:51], v[200:203], v[12:15], 0
    v_mfma_f32_16x16x32_bf16 v[52:55], v[204:207], v[12:15], 0
    s_nop 4
    v_mov_b32_dpp v36, v20 quad_perm:[0,0,0,0] row_mask:0xf bank_mask:0xf
    v_add_f32_dpp v36, v21, v36 quad_perm:[1,1,1,1] row_mask:0xf bank_mask:0xf
    v_add_f32_dpp v36, v22, v36 quad_perm:[2,2,2,2] row_mask:0xf bank_mask:0xf
    v_add_f32_dpp v36, v23, v36 quad_perm:[3,3,3,3] row_mask:0xf bank_mask:0xf
    v_mov_b32_dpp v37, v24 quad_perm:[0,0,0,0] row_mask:0xf bank_mask:0xf
    v_add_f32_dpp v37, v25, v37 quad_perm:[1,1,1,1] row_mask:0xf bank_mask:0xf
    v_add_f32_dpp v37, v26, v37 quad_perm:[2,2,2,2] row_mask:0xf bank_mask:0xf
    v_add_f32_dpp v37, v27, v37 quad_perm:[3,3,3,3] row_mask:0xf bank_mask:0xf
    v_mov_b32_dpp v38, v48 quad_perm:[0,0,0,0] row_mask:0xf bank_mask:0xf
    v_add_f32_dpp v38, v49, v38 quad_perm:[1,1,1,1] row_mask:0xf bank_mask:0xf
    v_add_f32_dpp v38, v50, v38 quad_perm:[2,2,2,2] row_mask:0xf bank_mask:0xf
    v_add_f32_dpp v38, v51, v38 quad_perm:[3,3,3,3] row_mask:0xf bank_mask:0xf
    v_mov_b32_dpp v39, v52 quad_perm:[0,0,0,0] row_mask:0xf bank_mask:0xf
    v_add_f32_dpp v39, v53, v39 quad_perm:[1,1,1,1] row_mask:0xf bank_mask:0xf
    v_add_f32_dpp v39, v54, v39 quad_perm:[2,2,2,2] row_mask:0xf bank_mask:0xf
    v_add_f32_dpp v39, v55, v39 quad_perm:[3,3,3,3] row_mask:0xf bank_mask:0xf
    v_cvt_pk_bf16_f32 v44, v36, v37
    v_cvt_pk_bf16_f32 v45, v38, v39
    v_lshlrev_b32 v36, 16, v44
    v_and_b32 v37, 0xffff0000, v44
    v_lshlrev_b32 v38, 16, v45
    v_and_b32 v39, 0xffff0000, v45
    v_mul_f32 v36, 0x3db504f3, v36
    v_mul_f32 v37, 0x3db504f3, v37
    v_mul_f32 v38, 0x3db504f3, v38
    v_mul_f32 v39, 0x3db504f3, v39
    v_cvt_pk_bf16_f32 v44, v36, v37
    v_cvt_pk_bf16_f32 v45, v38, v39
    v_lshlrev_b32 v36, 16, v44
    v_and_b32 v37, 0xffff0000, v44
    v_lshlrev_b32 v38, 16, v45
    v_and_b32 v39, 0xffff0000, v45
    v_mul_f32 v36, s8, v36
    v_mul_f32 v37, s8, v37
    v_mul_f32 v38, s8, v38
    v_mul_f32 v39, s8, v39
    v_floor_f32 v20, v36
    v_floor_f32 v21, v37
    v_floor_f32 v22, v38
    v_floor_f32 v23, v39
    v_max3_f32 v44, v20, v21, v22
    v_max3_f32 v44, v44, v23, v32
    v_sub_f32 v40, v36, v20
    v_sub_f32 v41, v37, v21
    v_sub_f32 v42, v38, v22
    v_sub_f32 v43, v39, v23
    v_mov_b32 v45, v44
    s_nop 1
    v_permlane16_swap_b32 v44, v45
    s_nop 1
    v_max_f32 v44, v44, v45
    v_mov_b32 v45, v44
    s_nop 1
    v_permlane32_swap_b32 v44, v45
    s_nop 1
    v_max_f32 v44, v44, v45
    v_exp_f32 v40, v40
    v_exp_f32 v41, v41
    v_exp_f32 v42, v42
    v_exp_f32 v43, v43
    v_sub_f32 v45, v32, v44
    v_cvt_i32_f32 v45, v45
    v_mov_b32 v32, v44
    v_sub_f32 v20, v20, v44
    v_sub_f32 v21, v21, v44
    v_sub_f32 v22, v22, v44
    v_sub_f32 v23, v23, v44
    v_cvt_i32_f32 v20, v20
    v_cvt_i32_f32 v21, v21
    v_cvt_i32_f32 v22, v22
    v_cvt_i32_f32 v23, v23
    v_ldexp_f32 v40, v40, v20
    v_ldexp_f32 v41, v41, v21
    v_ldexp_f32 v42, v42, v22
    v_ldexp_f32 v43, v43, v23
    v_ldexp_f32 v28, v28, v45
    v_ldexp_f32 v29, v29, v45
    v_ldexp_f32 v30, v30, v45
    v_ldexp_f32 v31, v31, v45
    v_ldexp_f32 v33, v33, v45
    v_add_f32 v46, v40, v41
    v_add_f32 v47, v42, v43
    v_add_f32 v46, v46, v47
    v_add_f32 v33, v33, v46
    v_cvt_pk_bf16_f32 v34, v40, v40
    v_and_b32 v48, v2, v34
    v_and_b32 v49, v3, v34
    v_and_b32 v50, v4, v34
    v_and_b32 v51, v5, v34
    v_cvt_pk_bf16_f32 v35, v41, v41
    v_and_b32 v52, v2, v35
    v_and_b32 v53, v3, v35
    v_and_b32 v54, v4, v35
    v_and_b32 v55, v5, v35
    v_cvt_pk_bf16_f32 v34, v42, v42
    v_and_b32 v56, v2, v34
    v_and_b32 v57, v3, v34
    v_and_b32 v58, v4, v34
    v_and_b32 v59, v5, v34
    v_cvt_pk_bf16_f32 v35, v43, v43
    v_and_b32 v60, v2, v35
    v_and_b32 v61, v3, v35
    v_and_b32 v62, v4, v35
    v_and_b32 v63, v5, v35
    s_nop 1
    v_mfma_f32_16x16x32_bf16 v[28:31], v[208:211], v[48:51], v[28:31]
    v_mfma_f32_16x16x32_bf16 v[28:31], v[212:215], v[52:55], v[28:31]
    v_mfma_f32_16x16x32_bf16 v[28:31], v[216:219], v[56:59], v[28:31]
    v_mfma_f32_16x16x32_bf16 v[28:31], v[220:223], v[60:63], v[28:31]
    s_waitcnt vmcnt(12)
    v_mfma_f32_16x16x32_bf16 v[20:23], v[224:227], v[12:15], 0
    v_mfma_f32_16x16x32_bf16 v[24:27], v[228:231], v[12:15], 0
    v_mfma_f32_16x16x32_bf16 v[48:51], v[232:235], v[12:15], 0
    v_mfma_f32_16x16x32_bf16 v[52:55], v[236:239], v[12:15], 0
    s_nop 4
    v_mov_b32_dpp v36, v20 quad_perm:[0,0,0,0] row_mask:0xf bank_mask:0xf
    v_add_f32_dpp v36, v21, v36 quad_perm:[1,1,1,1] row_mask:0xf bank_mask:0xf
    v_add_f32_dpp v36, v22, v36 quad_perm:[2,2,2,2] row_mask:0xf bank_mask:0xf
    v_add_f32_dpp v36, v23, v36 quad_perm:[3,3,3,3] row_mask:0xf bank_mask:0xf
    v_mov_b32_dpp v37, v24 quad_perm:[0,0,0,0] row_mask:0xf bank_mask:0xf
    v_add_f32_dpp v37, v25, v37 quad_perm:[1,1,1,1] row_mask:0xf bank_mask:0xf
    v_add_f32_dpp v37, v26, v37 quad_perm:[2,2,2,2] row_mask:0xf bank_mask:0xf
    v_add_f32_dpp v37, v27, v37 quad_perm:[3,3,3,3] row_mask:0xf bank_mask:0xf
    v_mov_b32_dpp v38, v48 quad_perm:[0,0,0,0] row_mask:0xf bank_mask:0xf
    v_add_f32_dpp v38, v49, v38 quad_perm:[1,1,1,1] row_mask:0xf bank_mask:0xf
    v_add_f32_dpp v38, v50, v38 quad_perm:[2,2,2,2] row_mask:0xf bank_mask:0xf
    v_add_f32_dpp v38, v51, v38 quad_perm:[3,3,3,3] row_mask:0xf bank_mask:0xf
    v_mov_b32_dpp v39, v52 quad_perm:[0,0,0,0] row_mask:0xf bank_mask:0xf
    v_add_f32_dpp v39, v53, v39 quad_perm:[1,1,1,1] row_mask:0xf bank_mask:0xf
    v_add_f32_dpp v39, v54, v39 quad_perm:[2,2,2,2] row_mask:0xf bank_mask:0xf
    v_add_f32_dpp v39, v55, v39 quad_perm:[3,3,3,3] row_mask:0xf bank_mask:0xf
    v_cvt_pk_bf16_f32 v44, v36, v37
    v_cvt_pk_bf16_f32 v45, v38, v39
    v_lshlrev_b32 v36, 16, v44
    v_and_b32 v37, 0xffff0000, v44
    v_lshlrev_b32 v38, 16, v45
    v_and_b32 v39, 0xffff0000, v45
    v_mul_f32 v36, 0x3db504f3, v36
    v_mul_f32 v37, 0x3db504f3, v37
    v_mul_f32 v38, 0x3db504f3, v38
    v_mul_f32 v39, 0x3db504f3, v39
    v_cvt_pk_bf16_f32 v44, v36, v37
    v_cvt_pk_bf16_f32 v45, v38, v39
    v_lshlrev_b32 v36, 16, v44
    v_and_b32 v37, 0xffff0000, v44
    v_lshlrev_b32 v38, 16, v45
    v_and_b32 v39, 0xffff0000, v45
    v_mul_f32 v36, s8, v36
    v_mul_f32 v37, s8, v37
    v_mul_f32 v38, s8, v38
    v_mul_f32 v39, s8, v39
    v_floor_f32 v20, v36
    v_floor_f32 v21, v37
    v_floor_f32 v22, v38
    v_floor_f32 v23, v39
    v_max3_f32 v44, v20, v21, v22
    v_max3_f32 v44, v44, v23, v32
    v_sub_f32 v40, v36, v20
    v_sub_f32 v41, v37, v21
    v_sub_f32 v42, v38, v22
    v_sub_f32 v43, v39, v23
    v_mov_b32 v45, v44
    s_nop 1
    v_permlane16_swap_b32 v44, v45
    s_nop 1
    v_max_f32 v44, v44, v45
    v_mov_b32 v45, v44
    s_nop 1
    v_permlane32_swap_b32 v44, v45
    s_nop 1
    v_max_f32 v44, v44, v45
    v_exp_f32 v40, v40
    v_exp_f32 v41, v41
    v_exp_f32 v42, v42
    v_exp_f32 v43, v43
    v_sub_f32 v45, v32, v44
    v_cvt_i32_f32 v45, v45
    v_mov_b32 v32, v44
    v_sub_f32 v20, v20, v44
    v_sub_f32 v21, v21, v44
    v_sub_f32 v22, v22, v44
    v_sub_f32 v23, v23, v44
    v_cvt_i32_f32 v20, v20
    v_cvt_i32_f32 v21, v21
    v_cvt_i32_f32 v22, v22
    v_cvt_i32_f32 v23, v23
    v_ldexp_f32 v40, v40, v20
    v_ldexp_f32 v41, v41, v21
    v_ldexp_f32 v42, v42, v22
    v_ldexp_f32 v43, v43, v23
    v_ldexp_f32 v28, v28, v45
    v_ldexp_f32 v29, v29, v45
    v_ldexp_f32 v30, v30, v45
    v_ldexp_f32 v31, v31, v45
    v_ldexp_f32 v33, v33, v45
    v_add_f32 v46, v40, v41
    v_add_f32 v47, v42, v43
    v_add_f32 v46, v46, v47
    v_add_f32 v33, v33, v46
    v_cvt_pk_bf16_f32 v34, v40, v40
    v_and_b32 v48, v2, v34
    v_and_b32 v49, v3, v34
    v_and_b32 v50, v4, v34
    v_and_b32 v51, v5, v34
    v_cvt_pk_bf16_f32 v35, v41, v41
    v_and_b32 v52, v2, v35
    v_and_b32 v53, v3, v35
    v_and_b32 v54, v4, v35
    v_and_b32 v55, v5, v35
    v_cvt_pk_bf16_f32 v34, v42, v42
    v_and_b32 v56, v2, v34
    v_and_b32 v57, v3, v34
    v_and_b32 v58, v4, v34
    v_and_b32 v59, v5, v34
    v_cvt_pk_bf16_f32 v35, v43, v43
    v_and_b32 v60, v2, v35
    v_and_b32 v61, v3, v35
    v_and_b32 v62, v4, v35
    v_and_b32 v63, v5, v35
    s_waitcnt vmcnt(8)
    s_nop 1
    v_mfma_f32_16x16x32_bf16 v[28:31], v[240:243], v[48:51], v[28:31]
    v_mfma_f32_16x16x32_bf16 v[28:31], v[244:247], v[52:55], v[28:31]
    v_mfma_f32_16x16x32_bf16 v[28:31], v[248:251], v[56:59], v[28:31]
    v_mfma_f32_16x16x32_bf16 v[28:31], v[252:255], v[60:63], v[28:31]
    s_branch L_tail
L_drain1:
    buffer_load_dwordx4 v[96:99], v8, s[48:51], s81 offen offset:0 nt
    buffer_load_dwordx4 v[100:103], v8, s[48:51], s81 offen offset:1152 nt
    buffer_load_dwordx4 v[104:107], v8, s[48:51], s81 offen offset:2304 nt
    buffer_load_dwordx4 v[108:111], v8, s[48:51], s81 offen offset:3456 nt
    buffer_load_dwordx4 v[112:115], v8, s[48:51], s82 offen offset:0 nt
    buffer_load_dwordx4 v[116:119], v8, s[48:51], s82 offen offset:1152 nt
    buffer_load_dwordx4 v[120:123], v8, s[48:51], s82 offen offset:2304 nt
    buffer_load_dwordx4 v[124:127], v8, s[48:51], s82 offen offset:3456 nt
    s_waitcnt vmcnt(16)
    v_mfma_f32_16x16x32_bf16 v[20:23], v[224:227], v[12:15], 0
    v_mfma_f32_16x16x32_bf16 v[24:27], v[228:231], v[12:15], 0
    v_mfma_f32_16x16x32_bf16 v[48:51], v[232:235], v[12:15], 0
    v_mfma_f32_16x16x32_bf16 v[52:55], v[236:239], v[12:15], 0
    s_nop 4
    v_mov_b32_dpp v36, v20 quad_perm:[0,0,0,0] row_mask:0xf bank_mask:0xf
    v_add_f32_dpp v36, v21, v36 quad_perm:[1,1,1,1] row_mask:0xf bank_mask:0xf
    v_add_f32_dpp v36, v22, v36 quad_perm:[2,2,2,2] row_mask:0xf bank_mask:0xf
    v_add_f32_dpp v36, v23, v36 quad_perm:[3,3,3,3] row_mask:0xf bank_mask:0xf
    v_mov_b32_dpp v37, v24 quad_perm:[0,0,0,0] row_mask:0xf bank_mask:0xf
    v_add_f32_dpp v37, v25, v37 quad_perm:[1,1,1,1] row_mask:0xf bank_mask:0xf
    v_add_f32_dpp v37, v26, v37 quad_perm:[2,2,2,2] row_mask:0xf bank_mask:0xf
    v_add_f32_dpp v37, v27, v37 quad_perm:[3,3,3,3] row_mask:0xf bank_mask:0xf
    v_mov_b32_dpp v38, v48 quad_perm:[0,0,0,0] row_mask:0xf bank_mask:0xf
    v_add_f32_dpp v38, v49, v38 quad_perm:[1,1,1,1] row_mask:0xf bank_mask:0xf
    v_add_f32_dpp v38, v50, v38 quad_perm:[2,2,2,2] row_mask:0xf bank_mask:0xf
    v_add_f32_dpp v38, v51, v38 quad_perm:[3,3,3,3] row_mask:0xf bank_mask:0xf
    v_mov_b32_dpp v39, v52 quad_perm:[0,0,0,0] row_mask:0xf bank_mask:0xf
    v_add_f32_dpp v39, v53, v39 quad_perm:[1,1,1,1] row_mask:0xf bank_mask:0xf
    v_add_f32_dpp v39, v54, v39 quad_perm:[2,2,2,2] row_mask:0xf bank_mask:0xf
    v_add_f32_dpp v39, v55, v39 quad_perm:[3,3,3,3] row_mask:0xf bank_mask:0xf
    v_cvt_pk_bf16_f32 v44, v36, v37
    v_cvt_pk_bf16_f32 v45, v38, v39
    v_lshlrev_b32 v36, 16, v44
    v_and_b32 v37, 0xffff0000, v44
    v_lshlrev_b32 v38, 16, v45
    v_and_b32 v39, 0xffff0000, v45
    v_mul_f32 v36, 0x3db504f3, v36
    v_mul_f32 v37, 0x3db504f3, v37
    v_mul_f32 v38, 0x3db504f3, v38
    v_mul_f32 v39, 0x3db504f3, v39
    v_cvt_pk_bf16_f32 v44, v36, v37
    v_cvt_pk_bf16_f32 v45, v38, v39
    v_lshlrev_b32 v36, 16, v44
    v_and_b32 v37, 0xffff0000, v44
    v_lshlrev_b32 v38, 16, v45
    v_and_b32 v39, 0xffff0000, v45
    v_mul_f32 v36, s8, v36
    v_mul_f32 v37, s8, v37
    v_mul_f32 v38, s8, v38
    v_mul_f32 v39, s8, v39
    v_floor_f32 v20, v36
    v_floor_f32 v21, v37
    v_floor_f32 v22, v38
    v_floor_f32 v23, v39
    v_max3_f32 v44, v20, v21, v22
    v_max3_f32 v44, v44, v23, v32
    v_sub_f32 v40, v36, v20
    v_sub_f32 v41, v37, v21
    v_sub_f32 v42, v38, v22
    v_sub_f32 v43, v39, v23
    v_mov_b32 v45, v44
    s_nop 1
    v_permlane16_swap_b32 v44, v45
    s_nop 1
    v_max_f32 v44, v44, v45
    v_mov_b32 v45, v44
    s_nop 1
    v_permlane32_swap_b32 v44, v45
    s_nop 1
    v_max_f32 v44, v44, v45
    v_exp_f32 v40, v40
    v_exp_f32 v41, v41
    v_exp_f32 v42, v42
    v_exp_f32 v43, v43
    v_sub_f32 v45, v32, v44
    v_cvt_i32_f32 v45, v45
    v_mov_b32 v32, v44
    v_sub_f32 v20, v20, v44
    v_sub_f32 v21, v21, v44
    v_sub_f32 v22, v22, v44
    v_sub_f32 v23, v23, v44
    v_cvt_i32_f32 v20, v20
    v_cvt_i32_f32 v21, v21
    v_cvt_i32_f32 v22, v22
    v_cvt_i32_f32 v23, v23
    v_ldexp_f32 v40, v40, v20
    v_ldexp_f32 v41, v41, v21
    v_ldexp_f32 v42, v42, v22
    v_ldexp_f32 v43, v43, v23
    v_ldexp_f32 v28, v28, v45
    v_ldexp_f32 v29, v29, v45
    v_ldexp_f32 v30, v30, v45
    v_ldexp_f32 v31, v31, v45
    v_ldexp_f32 v33, v33, v45
    v_add_f32 v46, v40, v41
    v_add_f32 v47, v42, v43
    v_add_f32 v46, v46, v47
    v_add_f32 v33, v33, v46
    v_cvt_pk_bf16_f32 v34, v40, v40
    v_and_b32 v48, v2, v34
    v_and_b32 v49, v3, v34
    v_and_b32 v50, v4, v34
    v_and_b32 v51, v5, v34
    v_cvt_pk_bf16_f32 v35, v41, v41
    v_and_b32 v52, v2, v35
    v_and_b32 v53, v3, v35
    v_and_b32 v54, v4, v35
    v_and_b32 v55, v5, v35
    v_cvt_pk_bf16_f32 v34, v42, v42
    v_and_b32 v56, v2, v34
    v_and_b32 v57, v3, v34
    v_and_b32 v58, v4, v34
    v_and_b32 v59, v5, v34
    v_cvt_pk_bf16_f32 v35, v43, v43
    v_and_b32 v60, v2, v35
    v_and_b32 v61, v3, v35
    v_and_b32 v62, v4, v35
    v_and_b32 v63, v5, v35
    s_nop 1
    v_mfma_f32_16x16x32_bf16 v[28:31], v[240:243], v[48:51], v[28:31]
    v_mfma_f32_16x16x32_bf16 v[28:31], v[244:247], v[52:55], v[28:31]
    v_mfma_f32_16x16x32_bf16 v[28:31], v[248:251], v[56:59], v[28:31]
    v_mfma_f32_16x16x32_bf16 v[28:31], v[252:255], v[60:63], v[28:31]
    s_waitcnt vmcnt(12)
    v_mfma_f32_16x16x32_bf16 v[20:23], v[64:67], v[12:15], 0
    v_mfma_f32_16x16x32_bf16 v[24:27], v[68:71], v[12:15], 0
    v_mfma_f32_16x16x32_bf16 v[48:51], v[72:75], v[12:15], 0
    v_mfma_f32_16x16x32_bf16 v[52:55], v[76:79], v[12:15], 0
    s_nop 4
    v_mov_b32_dpp v36, v20 quad_perm:[0,0,0,0] row_mask:0xf bank_mask:0xf
    v_add_f32_dpp v36, v21, v36 quad_perm:[1,1,1,1] row_mask:0xf bank_mask:0xf
    v_add_f32_dpp v36, v22, v36 quad_perm:[2,2,2,2] row_mask:0xf bank_mask:0xf
    v_add_f32_dpp v36, v23, v36 quad_perm:[3,3,3,3] row_mask:0xf bank_mask:0xf
    v_mov_b32_dpp v37, v24 quad_perm:[0,0,0,0] row_mask:0xf bank_mask:0xf
    v_add_f32_dpp v37, v25, v37 quad_perm:[1,1,1,1] row_mask:0xf bank_mask:0xf
    v_add_f32_dpp v37, v26, v37 quad_perm:[2,2,2,2] row_mask:0xf bank_mask:0xf
    v_add_f32_dpp v37, v27, v37 quad_perm:[3,3,3,3] row_mask:0xf bank_mask:0xf
    v_mov_b32_dpp v38, v48 quad_perm:[0,0,0,0] row_mask:0xf bank_mask:0xf
    v_add_f32_dpp v38, v49, v38 quad_perm:[1,1,1,1] row_mask:0xf bank_mask:0xf
    v_add_f32_dpp v38, v50, v38 quad_perm:[2,2,2,2] row_mask:0xf bank_mask:0xf
    v_add_f32_dpp v38, v51, v38 quad_perm:[3,3,3,3] row_mask:0xf bank_mask:0xf
    v_mov_b32_dpp v39, v52 quad_perm:[0,0,0,0] row_mask:0xf bank_mask:0xf
    v_add_f32_dpp v39, v53, v39 quad_perm:[1,1,1,1] row_mask:0xf bank_mask:0xf
    v_add_f32_dpp v39, v54, v39 quad_perm:[2,2,2,2] row_mask:0xf bank_mask:0xf
    v_add_f32_dpp v39, v55, v39 quad_perm:[3,3,3,3] row_mask:0xf bank_mask:0xf
    v_cvt_pk_bf16_f32 v44, v36, v37
    v_cvt_pk_bf16_f32 v45, v38, v39
    v_lshlrev_b32 v36, 16, v44
    v_and_b32 v37, 0xffff0000, v44
    v_lshlrev_b32 v38, 16, v45
    v_and_b32 v39, 0xffff0000, v45
    v_mul_f32 v36, 0x3db504f3, v36
    v_mul_f32 v37, 0x3db504f3, v37
    v_mul_f32 v38, 0x3db504f3, v38
    v_mul_f32 v39, 0x3db504f3, v39
    v_cvt_pk_bf16_f32 v44, v36, v37
    v_cvt_pk_bf16_f32 v45, v38, v39
    v_lshlrev_b32 v36, 16, v44
    v_and_b32 v37, 0xffff0000, v44
    v_lshlrev_b32 v38, 16, v45
    v_and_b32 v39, 0xffff0000, v45
    v_mul_f32 v36, s8, v36
    v_mul_f32 v37, s8, v37
    v_mul_f32 v38, s8, v38
    v_mul_f32 v39, s8, v39
    v_floor_f32 v20, v36
    v_floor_f32 v21, v37
    v_floor_f32 v22, v38
    v_floor_f32 v23, v39
    v_max3_f32 v44, v20, v21, v22
    v_max3_f32 v44, v44, v23, v32
    v_sub_f32 v40, v36, v20
    v_sub_f32 v41, v37, v21
    v_sub_f32 v42, v38, v22
    v_sub_f32 v43, v39, v23
    v_mov_b32 v45, v44
    s_nop 1
    v_permlane16_swap_b32 v44, v45
    s_nop 1
    v_max_f32 v44, v44, v45
    v_mov_b32 v45, v44
    s_nop 1
    v_permlane32_swap_b32 v44, v45
    s_nop 1
    v_max_f32 v44, v44, v45
    v_exp_f32 v40, v40
    v_exp_f32 v41, v41
    v_exp_f32 v42, v42
    v_exp_f32 v43, v43
    v_sub_f32 v45, v32, v44
    v_cvt_i32_f32 v45, v45
    v_mov_b32 v32, v44
    v_sub_f32 v20, v20, v44
    v_sub_f32 v21, v21, v44
    v_sub_f32 v22, v22, v44
    v_sub_f32 v23, v23, v44
    v_cvt_i32_f32 v20, v20
    v_cvt_i32_f32 v21, v21
    v_cvt_i32_f32 v22, v22
    v_cvt_i32_f32 v23, v23
    v_ldexp_f32 v40, v40, v20
    v_ldexp_f32 v41, v41, v21
    v_ldexp_f32 v42, v42, v22
    v_ldexp_f32 v43, v43, v23
    v_ldexp_f32 v28, v28, v45
    v_ldexp_f32 v29, v29, v45
    v_ldexp_f32 v30, v30, v45
    v_ldexp_f32 v31, v31, v45
    v_ldexp_f32 v33, v33, v45
    v_add_f32 v46, v40, v41
    v_add_f32 v47, v42, v43
    v_add_f32 v46, v46, v47
    v_add_f32 v33, v33, v46
    v_cvt_pk_bf16_f32 v34, v40, v40
    v_and_b32 v48, v2, v34
    v_and_b32 v49, v3, v34
    v_and_b32 v50, v4, v34
    v_and_b32 v51, v5, v34
    v_cvt_pk_bf16_f32 v35, v41, v41
    v_and_b32 v52, v2, v35
    v_and_b32 v53, v3, v35
    v_and_b32 v54, v4, v35
    v_and_b32 v55, v5, v35
    v_cvt_pk_bf16_f32 v34, v42, v42
    v_and_b32 v56, v2, v34
    v_and_b32 v57, v3, v34
    v_and_b32 v58, v4, v34
    v_and_b32 v59, v5, v34
    v_cvt_pk_bf16_f32 v35, v43, v43
    v_and_b32 v60, v2, v35
    v_and_b32 v61, v3, v35
    v_and_b32 v62, v4, v35
    v_and_b32 v63, v5, v35
    s_waitcnt vmcnt(8)
    s_nop 1
    v_mfma_f32_16x16x32_bf16 v[28:31], v[80:83], v[48:51], v[28:31]
    v_mfma_f32_16x16x32_bf16 v[28:31], v[84:87], v[52:55], v[28:31]
    v_mfma_f32_16x16x32_bf16 v[28:31], v[88:91], v[56:59], v[28:31]
    v_mfma_f32_16x16x32_bf16 v[28:31], v[92:95], v[60:63], v[28:31]
    s_branch L_tail
L_drain2:
    buffer_load_dwordx4 v[96:99], v8, s[48:51], s81 offen offset:0 nt
    buffer_load_dwordx4 v[100:103], v8, s[48:51], s81 offen offset:1152 nt
    buffer_load_dwordx4 v[104:107], v8, s[48:51], s81 offen offset:2304 nt
    buffer_load_dwordx4 v[108:111], v8, s[48:51], s81 offen offset:3456 nt
    buffer_load_dwordx4 v[112:115], v8, s[48:51], s82 offen offset:0 nt
    buffer_load_dwordx4 v[116:119], v8, s[48:51], s82 offen offset:1152 nt
    buffer_load_dwordx4 v[120:123], v8, s[48:51], s82 offen offset:2304 nt
    buffer_load_dwordx4 v[124:127], v8, s[48:51], s82 offen offset:3456 nt
    s_waitcnt vmcnt(16)
    v_mfma_f32_16x16x32_bf16 v[20:23], v[64:67], v[12:15], 0
    v_mfma_f32_16x16x32_bf16 v[24:27], v[68:71], v[12:15], 0
    v_mfma_f32_16x16x32_bf16 v[48:51], v[72:75], v[12:15], 0
    v_mfma_f32_16x16x32_bf16 v[52:55], v[76:79], v[12:15], 0
    s_nop 4
    v_mov_b32_dpp v36, v20 quad_perm:[0,0,0,0] row_mask:0xf bank_mask:0xf
    v_add_f32_dpp v36, v21, v36 quad_perm:[1,1,1,1] row_mask:0xf bank_mask:0xf
    v_add_f32_dpp v36, v22, v36 quad_perm:[2,2,2,2] row_mask:0xf bank_mask:0xf
    v_add_f32_dpp v36, v23, v36 quad_perm:[3,3,3,3] row_mask:0xf bank_mask:0xf
    v_mov_b32_dpp v37, v24 quad_perm:[0,0,0,0] row_mask:0xf bank_mask:0xf
    v_add_f32_dpp v37, v25, v37 quad_perm:[1,1,1,1] row_mask:0xf bank_mask:0xf
    v_add_f32_dpp v37, v26, v37 quad_perm:[2,2,2,2] row_mask:0xf bank_mask:0xf
    v_add_f32_dpp v37, v27, v37 quad_perm:[3,3,3,3] row_mask:0xf bank_mask:0xf
    v_mov_b32_dpp v38, v48 quad_perm:[0,0,0,0] row_mask:0xf bank_mask:0xf
    v_add_f32_dpp v38, v49, v38 quad_perm:[1,1,1,1] row_mask:0xf bank_mask:0xf
    v_add_f32_dpp v38, v50, v38 quad_perm:[2,2,2,2] row_mask:0xf bank_mask:0xf
    v_add_f32_dpp v38, v51, v38 quad_perm:[3,3,3,3] row_mask:0xf bank_mask:0xf
    v_mov_b32_dpp v39, v52 quad_perm:[0,0,0,0] row_mask:0xf bank_mask:0xf
    v_add_f32_dpp v39, v53, v39 quad_perm:[1,1,1,1] row_mask:0xf bank_mask:0xf
    v_add_f32_dpp v39, v54, v39 quad_perm:[2,2,2,2] row_mask:0xf bank_mask:0xf
    v_add_f32_dpp v39, v55, v39 quad_perm:[3,3,3,3] row_mask:0xf bank_mask:0xf
    v_cvt_pk_bf16_f32 v44, v36, v37
    v_cvt_pk_bf16_f32 v45, v38, v39
    v_lshlrev_b32 v36, 16, v44
    v_and_b32 v37, 0xffff0000, v44
    v_lshlrev_b32 v38, 16, v45
    v_and_b32 v39, 0xffff0000, v45
    v_mul_f32 v36, 0x3db504f3, v36
    v_mul_f32 v37, 0x3db504f3, v37
    v_mul_f32 v38, 0x3db504f3, v38
    v_mul_f32 v39, 0x3db504f3, v39
    v_cvt_pk_bf16_f32 v44, v36, v37
    v_cvt_pk_bf16_f32 v45, v38, v39
    v_lshlrev_b32 v36, 16, v44
    v_and_b32 v37, 0xffff0000, v44
    v_lshlrev_b32 v38, 16, v45
    v_and_b32 v39, 0xffff0000, v45
    v_mul_f32 v36, s8, v36
    v_mul_f32 v37, s8, v37
    v_mul_f32 v38, s8, v38
    v_mul_f32 v39, s8, v39
    v_floor_f32 v20, v36
    v_floor_f32 v21, v37
    v_floor_f32 v22, v38
    v_floor_f32 v23, v39
    v_max3_f32 v44, v20, v21, v22
    v_max3_f32 v44, v44, v23, v32
    v_sub_f32 v40, v36, v20
    v_sub_f32 v41, v37, v21
    v_sub_f32 v42, v38, v22
    v_sub_f32 v43, v39, v23
    v_mov_b32 v45, v44
    s_nop 1
    v_permlane16_swap_b32 v44, v45
    s_nop 1
    v_max_f32 v44, v44, v45
    v_mov_b32 v45, v44
    s_nop 1
    v_permlane32_swap_b32 v44, v45
    s_nop 1
    v_max_f32 v44, v44, v45
    v_exp_f32 v40, v40
    v_exp_f32 v41, v41
    v_exp_f32 v42, v42
    v_exp_f32 v43, v43
    v_sub_f32 v45, v32, v44
    v_cvt_i32_f32 v45, v45
    v_mov_b32 v32, v44
    v_sub_f32 v20, v20, v44
    v_sub_f32 v21, v21, v44
    v_sub_f32 v22, v22, v44
    v_sub_f32 v23, v23, v44
    v_cvt_i32_f32 v20, v20
    v_cvt_i32_f32 v21, v21
    v_cvt_i32_f32 v22, v22
    v_cvt_i32_f32 v23, v23
    v_ldexp_f32 v40, v40, v20
    v_ldexp_f32 v41, v41, v21
    v_ldexp_f32 v42, v42, v22
    v_ldexp_f32 v43, v43, v23
    v_ldexp_f32 v28, v28, v45
    v_ldexp_f32 v29, v29, v45
    v_ldexp_f32 v30, v30, v45
    v_ldexp_f32 v31, v31, v45
    v_ldexp_f32 v33, v33, v45
    v_add_f32 v46, v40, v41
    v_add_f32 v47, v42, v43
    v_add_f32 v46, v46, v47
    v_add_f32 v33, v33, v46
    v_cvt_pk_bf16_f32 v34, v40, v40
    v_and_b32 v48, v2, v34
    v_and_b32 v49, v3, v34
    v_and_b32 v50, v4, v34
    v_and_b32 v51, v5, v34
    v_cvt_pk_bf16_f32 v35, v41, v41
    v_and_b32 v52, v2, v35
    v_and_b32 v53, v3, v35
    v_and_b32 v54, v4, v35
    v_and_b32 v55, v5, v35
    v_cvt_pk_bf16_f32 v34, v42, v42
    v_and_b32 v56, v2, v34
    v_and_b32 v57, v3, v34
    v_and_b32 v58, v4, v34
    v_and_b32 v59, v5, v34
    v_cvt_pk_bf16_f32 v35, v43, v43
    v_and_b32 v60, v2, v35
    v_and_b32 v61, v3, v35
    v_and_b32 v62, v4, v35
    v_and_b32 v63, v5, v35
    s_nop 1
    v_mfma_f32_16x16x32_bf16 v[28:31], v[80:83], v[48:51], v[28:31]
    v_mfma_f32_16x16x32_bf16 v[28:31], v[84:87], v[52:55], v[28:31]
    v_mfma_f32_16x16x32_bf16 v[28:31], v[88:91], v[56:59], v[28:31]
    v_mfma_f32_16x16x32_bf16 v[28:31], v[92:95], v[60:63], v[28:31]
    s_waitcnt vmcnt(12)
    v_mfma_f32_16x16x32_bf16 v[20:23], v[192:195], v[12:15], 0
    v_mfma_f32_16x16x32_bf16 v[24:27], v[196:199], v[12:15], 0
    v_mfma_f32_16x16x32_bf16 v[48:51], v[200:203], v[12:15], 0
    v_mfma_f32_16x16x32_bf16 v[52:55], v[204:207], v[12:15], 0
    s_nop 4
    v_mov_b32_dpp v36, v20 quad_perm:[0,0,0,0] row_mask:0xf bank_mask:0xf
    v_add_f32_dpp v36, v21, v36 quad_perm:[1,1,1,1] row_mask:0xf bank_mask:0xf
    v_add_f32_dpp v36, v22, v36 quad_perm:[2,2,2,2] row_mask:0xf bank_mask:0xf
    v_add_f32_dpp v36, v23, v36 quad_perm:[3,3,3,3] row_mask:0xf bank_mask:0xf
    v_mov_b32_dpp v37, v24 quad_perm:[0,0,0,0] row_mask:0xf bank_mask:0xf
    v_add_f32_dpp v37, v25, v37 quad_perm:[1,1,1,1] row_mask:0xf bank_mask:0xf
    v_add_f32_dpp v37, v26, v37 quad_perm:[2,2,2,2] row_mask:0xf bank_mask:0xf
    v_add_f32_dpp v37, v27, v37 quad_perm:[3,3,3,3] row_mask:0xf bank_mask:0xf
    v_mov_b32_dpp v38, v48 quad_perm:[0,0,0,0] row_mask:0xf bank_mask:0xf
    v_add_f32_dpp v38, v49, v38 quad_perm:[1,1,1,1] row_mask:0xf bank_mask:0xf
    v_add_f32_dpp v38, v50, v38 quad_perm:[2,2,2,2] row_mask:0xf bank_mask:0xf
    v_add_f32_dpp v38, v51, v38 quad_perm:[3,3,3,3] row_mask:0xf bank_mask:0xf
    v_mov_b32_dpp v39, v52 quad_perm:[0,0,0,0] row_mask:0xf bank_mask:0xf
    v_add_f32_dpp v39, v53, v39 quad_perm:[1,1,1,1] row_mask:0xf bank_mask:0xf
    v_add_f32_dpp v39, v54, v39 quad_perm:[2,2,2,2] row_mask:0xf bank_mask:0xf
    v_add_f32_dpp v39, v55, v39 quad_perm:[3,3,3,3] row_mask:0xf bank_mask:0xf
    v_cvt_pk_bf16_f32 v44, v36, v37
    v_cvt_pk_bf16_f32 v45, v38, v39
    v_lshlrev_b32 v36, 16, v44
    v_and_b32 v37, 0xffff0000, v44
    v_lshlrev_b32 v38, 16, v45
    v_and_b32 v39, 0xffff0000, v45
    v_mul_f32 v36, 0x3db504f3, v36
    v_mul_f32 v37, 0x3db504f3, v37
    v_mul_f32 v38, 0x3db504f3, v38
    v_mul_f32 v39, 0x3db504f3, v39
    v_cvt_pk_bf16_f32 v44, v36, v37
    v_cvt_pk_bf16_f32 v45, v38, v39
    v_lshlrev_b32 v36, 16, v44
    v_and_b32 v37, 0xffff0000, v44
    v_lshlrev_b32 v38, 16, v45
    v_and_b32 v39, 0xffff0000, v45
    v_mul_f32 v36, s8, v36
    v_mul_f32 v37, s8, v37
    v_mul_f32 v38, s8, v38
    v_mul_f32 v39, s8, v39
    v_floor_f32 v20, v36
    v_floor_f32 v21, v37
    v_floor_f32 v22, v38
    v_floor_f32 v23, v39
    v_max3_f32 v44, v20, v21, v22
    v_max3_f32 v44, v44, v23, v32
    v_sub_f32 v40, v36, v20
    v_sub_f32 v41, v37, v21
    v_sub_f32 v42, v38, v22
    v_sub_f32 v43, v39, v23
    v_mov_b32 v45, v44
    s_nop 1
    v_permlane16_swap_b32 v44, v45
    s_nop 1
    v_max_f32 v44, v44, v45
    v_mov_b32 v45, v44
    s_nop 1
    v_permlane32_swap_b32 v44, v45
    s_nop 1
    v_max_f32 v44, v44, v45
    v_exp_f32 v40, v40
    v_exp_f32 v41, v41
    v_exp_f32 v42, v42
    v_exp_f32 v43, v43
    v_sub_f32 v45, v32, v44
    v_cvt_i32_f32 v45, v45
    v_mov_b32 v32, v44
    v_sub_f32 v20, v20, v44
    v_sub_f32 v21, v21, v44
    v_sub_f32 v22, v22, v44
    v_sub_f32 v23, v23, v44
    v_cvt_i32_f32 v20, v20
    v_cvt_i32_f32 v21, v21
    v_cvt_i32_f32 v22, v22
    v_cvt_i32_f32 v23, v23
    v_ldexp_f32 v40, v40, v20
    v_ldexp_f32 v41, v41, v21
    v_ldexp_f32 v42, v42, v22
    v_ldexp_f32 v43, v43, v23
    v_ldexp_f32 v28, v28, v45
    v_ldexp_f32 v29, v29, v45
    v_ldexp_f32 v30, v30, v45
    v_ldexp_f32 v31, v31, v45
    v_ldexp_f32 v33, v33, v45
    v_add_f32 v46, v40, v41
    v_add_f32 v47, v42, v43
    v_add_f32 v46, v46, v47
    v_add_f32 v33, v33, v46
    v_cvt_pk_bf16_f32 v34, v40, v40
    v_and_b32 v48, v2, v34
    v_and_b32 v49, v3, v34
    v_and_b32 v50, v4, v34
    v_and_b32 v51, v5, v34
    v_cvt_pk_bf16_f32 v35, v41, v41
    v_and_b32 v52, v2, v35
    v_and_b32 v53, v3, v35
    v_and_b32 v54, v4, v35
    v_and_b32 v55, v5, v35
    v_cvt_pk_bf16_f32 v34, v42, v42
    v_and_b32 v56, v2, v34
    v_and_b32 v57, v3, v34
    v_and_b32 v58, v4, v34
    v_and_b32 v59, v5, v34
    v_cvt_pk_bf16_f32 v35, v43, v43
    v_and_b32 v60, v2, v35
    v_and_b32 v61, v3, v35
    v_and_b32 v62, v4, v35
    v_and_b32 v63, v5, v35
    s_waitcnt vmcnt(8)
    s_nop 1
    v_mfma_f32_16x16x32_bf16 v[28:31], v[208:211], v[48:51], v[28:31]
    v_mfma_f32_16x16x32_bf16 v[28:31], v[212:215], v[52:55], v[28:31]
    v_mfma_f32_16x16x32_bf16 v[28:31], v[216:219], v[56:59], v[28:31]
    v_mfma_f32_16x16x32_bf16 v[28:31], v[220:223], v[60:63], v[28:31]
L_tail:
    v_mov_b32 v44, v33
    s_nop 1
    v_permlane16_swap_b32 v33, v44
    s_nop 1
    v_add_f32 v33, v33, v44
    v_mov_b32 v44, v33
    s_nop 1
    v_permlane32_swap_b32 v33, v44
    s_nop 1
    v_add_f32 v33, v33, v44
    s_mul_i32 s10, s3, 1088
    v_and_b32 v11, 7, v0
    v_lshl_add_u32 v11, v6, 5, v11
    v_lshl_add_u32 v11, v7, 7, v11
    v_lshl_add_u32 v11, v11, 2, s10
    v_lshl_add_u32 v44, v7, 3, s10
    ds_write_b32 v11, v28 offset:2240
    ds_write_b32 v11, v29 offset:2272
    ds_write_b32 v11, v30 offset:2304
    ds_write_b32 v11, v31 offset:2336
    ds_write_b64 v44, v[32:33] offset:3264
    s_lshl_b32 s10, s3, 8
    v_lshl_add_u32 v11, v0, 2, s10
    s_lshr_b32 s77, s3, 1
    s_lshl_b32 s12, s77, 3
    v_mov_b32 v44, s12
    s_waitcnt lgkmcnt(0)
    s_barrier
    ds_read_b32 v132, v11 offset:2240
    ds_read_b64 v[136:137], v44 offset:3264
    ds_read_b32 v133, v11 offset:3328
    ds_read_b64 v[138:139], v44 offset:4352
    ds_read_b32 v134, v11 offset:4416
    ds_read_b64 v[140:141], v44 offset:5440
    ds_read_b32 v135, v11 offset:5504
    ds_read_b64 v[142:143], v44 offset:6528
    v_lshlrev_b32 v11, 1, v11
    v_mov_b32 v145, s79
    v_mov_b32 v147, s79
    v_mov_b32 v149, s79
    s_lshl_b32 s12, s4, 4
    s_add_u32 s12, s12, s5
    s_lshl_b32 s12, s12, 11
    s_add_u32 s12, s12, 327680
    s_lshl_b32 s13, s4, 1
    s_add_u32 s13, s13, s77
    s_lshl_b32 s13, s13, 8
    s_add_u32 s13, s13, 851968
    s_waitcnt lgkmcnt(0)
    v_max3_f32 v144, v136, v138, v140
    v_max_f32 v144, v144, v142
    v_sub_f32 v136, v136, v144
    v_cvt_i32_f32 v136, v136
    v_sub_f32 v138, v138, v144
    v_cvt_i32_f32 v138, v138
    v_sub_f32 v140, v140, v144
    v_cvt_i32_f32 v140, v140
    v_sub_f32 v142, v142, v144
    v_cvt_i32_f32 v142, v142
    v_ldexp_f32 v132, v132, v136
    v_ldexp_f32 v137, v137, v136
    v_ldexp_f32 v133, v133, v138
    v_ldexp_f32 v139, v139, v138
    v_ldexp_f32 v134, v134, v140
    v_ldexp_f32 v141, v141, v140
    v_ldexp_f32 v135, v135, v142
    v_ldexp_f32 v143, v143, v142
    v_add_f32 v148, v132, v133
    v_add_f32 v146, v137, v139
    v_add_f32 v148, v148, v134
    v_add_f32 v146, v146, v141
    v_add_f32 v148, v148, v135
    v_add_f32 v146, v146, v143
    buffer_store_dwordx2 v[148:149], v11, s[52:55], s12 offen sc1
    s_and_b32 s12, s3, 1
    s_cmp_lg_u32 s12, 0
    s_cbranch_scc1 L_noml
    s_lshl_b32 s12, s5, 4
    v_mov_b32 v44, s12
    s_mov_b64 exec, 1
    buffer_store_dwordx2 v[144:145], v44, s[52:55], s13 offen sc1
    buffer_store_dwordx2 v[146:147], v44, s[52:55], s13 offen offset:8 sc1
    s_mov_b64 exec, -1
L_noml:
    s_cmp_lt_u32 s5, 9
    s_cbranch_scc1 L_wo
    s_cmp_lg_u32 s5, 13
    s_cbranch_scc1 L_end
    s_cmp_ge_u32 s4, 9
    s_cbranch_scc1 L_end
    s_cmp_lg_u32 s3, 0
    s_cbranch_scc1 L_end
    s_branch L_final
L_wo:
    s_lshl_b32 s68, s4, 15
    s_add_u32 s68, s68, 327680
    s_add_u32 s69, s68, 4096
    s_add_u32 s70, s68, 8192
    s_add_u32 s71, s68, 12288
    s_add_u32 s72, s68, 16384
    s_add_u32 s73, s68, 20480
    s_add_u32 s74, s68, 24576
    s_add_u32 s75, s68, 28672
    v_and_b32 v12, 15, v0
    v_lshlrev_b32 v12, 4, v12
    s_mov_b32 s12, 262144
L_poll1:
    buffer_load_dwordx4 v[160:163], v12, s[52:55], s13 offen sc1
    buffer_load_dwordx2 v[164:165], v11, s[52:55], s68 offen offset:0 sc1
    buffer_load_dwordx2 v[166:167], v11, s[52:55], s68 offen offset:2048 sc1
    buffer_load_dwordx2 v[168:169], v11, s[52:55], s69 offen offset:0 sc1
    buffer_load_dwordx2 v[170:171], v11, s[52:55], s69 offen offset:2048 sc1
    buffer_load_dwordx2 v[172:173], v11, s[52:55], s70 offen offset:0 sc1
    buffer_load_dwordx2 v[174:175], v11, s[52:55], s70 offen offset:2048 sc1
    buffer_load_dwordx2 v[176:177], v11, s[52:55], s71 offen offset:0 sc1
    buffer_load_dwordx2 v[178:179], v11, s[52:55], s71 offen offset:2048 sc1
    buffer_load_dwordx2 v[180:181], v11, s[52:55], s72 offen offset:0 sc1
    buffer_load_dwordx2 v[182:183], v11, s[52:55], s72 offen offset:2048 sc1
    buffer_load_dwordx2 v[184:185], v11, s[52:55], s73 offen offset:0 sc1
    buffer_load_dwordx2 v[186:187], v11, s[52:55], s73 offen offset:2048 sc1
    buffer_load_dwordx2 v[188:189], v11, s[52:55], s74 offen offset:0 sc1
    buffer_load_dwordx2 v[190:191], v11, s[52:55], s74 offen offset:2048 sc1
    buffer_load_dwordx2 v[192:193], v11, s[52:55], s75 offen offset:0 sc1
    buffer_load_dwordx2 v[194:195], v11, s[52:55], s75 offen offset:2048 sc1
    s_waitcnt vmcnt(0)
    v_max_u32 v44, v161, v163
    v_min_u32 v45, v161, v163
    v_max3_u32 v44, v44, v165, v167
    v_min3_u32 v45, v45, v165, v167
    v_max3_u32 v44, v44, v169, v171
    v_min3_u32 v45, v45, v169, v171
    v_max3_u32 v44, v44, v173, v175
    v_min3_u32 v45, v45, v173, v175
    v_max3_u32 v44, v44, v177, v179
    v_min3_u32 v45, v45, v177, v179
    v_max3_u32 v44, v44, v181, v183
    v_min3_u32 v45, v45, v181, v183
    v_max3_u32 v44, v44, v185, v187
    v_min3_u32 v45, v45, v185, v187
    v_max3_u32 v44, v44, v189, v191
    v_min3_u32 v45, v45, v189, v191
    v_max3_u32 v44, v44, v193, v195
    v_min3_u32 v45, v45, v193, v195
    v_xor_b32 v44, s79, v44
    v_xor_b32 v45, s79, v45
    v_or_b32 v44, v44, v45
    v_cmp_ne_u32 vcc, 0, v44
    s_sub_u32 s12, s12, 1
    s_cmp_eq_u32 s12, 0
    s_cbranch_scc1 L_poll1_done
    s_cbranch_vccnz L_poll1
L_poll1_done:
    v_mov_b32 v44, v160
    s_nop 1
    v_max_f32_dpp v44, v44, v44 quad_perm:[1,0,3,2] row_mask:0xf bank_mask:0xf
    s_nop 1
    v_max_f32_dpp v44, v44, v44 quad_perm:[2,3,0,1] row_mask:0xf bank_mask:0xf
    s_nop 1
    v_max_f32_dpp v44, v44, v44 row_half_mirror row_mask:0xf bank_mask:0xf
    s_nop 1
    v_max_f32_dpp v44, v44, v44 row_mirror row_mask:0xf bank_mask:0xf
    v_sub_f32 v44, v160, v44
    v_cvt_i32_f32 v44, v44
    v_ldexp_f32 v45, v162, v44
    v_ldexp_f32 v44, 1.0, v44
    s_nop 1
    v_add_f32_dpp v45, v45, v45 quad_perm:[1,0,3,2] row_mask:0xf bank_mask:0xf
    s_nop 1
    v_add_f32_dpp v45, v45, v45 quad_perm:[2,3,0,1] row_mask:0xf bank_mask:0xf
    s_nop 1
    v_add_f32_dpp v45, v45, v45 row_half_mirror row_mask:0xf bank_mask:0xf
    s_nop 1
    v_add_f32_dpp v45, v45, v45 row_mirror row_mask:0xf bank_mask:0xf
    v_rcp_f32 v45, v45
    v_readlane_b32 s16, v44, 0
    v_readlane_b32 s17, v44, 1
    v_readlane_b32 s18, v44, 2
    v_readlane_b32 s19, v44, 3
    v_readlane_b32 s20, v44, 4
    v_readlane_b32 s21, v44, 5
    v_readlane_b32 s22, v44, 6
    v_readlane_b32 s23, v44, 7
    v_readlane_b32 s24, v44, 8
    v_readlane_b32 s25, v44, 9
    v_readlane_b32 s26, v44, 10
    v_readlane_b32 s27, v44, 11
    v_readlane_b32 s28, v44, 12
    v_readlane_b32 s29, v44, 13
    v_readlane_b32 s30, v44, 14
    v_readlane_b32 s31, v44, 15
    s_nop 1
    v_mul_f32 v46, s16, v164
    v_fmac_f32 v46, s17, v166
    v_fmac_f32 v46, s18, v168
    v_fmac_f32 v46, s19, v170
    v_fmac_f32 v46, s20, v172
    v_fmac_f32 v46, s21, v174
    v_fmac_f32 v46, s22, v176
    v_fmac_f32 v46, s23, v178
    v_fmac_f32 v46, s24, v180
    v_fmac_f32 v46, s25, v182
    v_fmac_f32 v46, s26, v184
    v_fmac_f32 v46, s27, v186
    v_fmac_f32 v46, s28, v188
    v_fmac_f32 v46, s29, v190
    v_fmac_f32 v46, s30, v192
    v_fmac_f32 v46, s31, v194
    v_mul_f32 v46, v46, v45
    v_cvt_pk_bf16_f32 v46, v46, v46
    s_lshl_b32 s12, s3, 7
    v_lshl_add_u32 v12, v0, 1, s12
    ds_write_b16 v12, v46 offset:6592
    v_lshrrev_b32 v12, 3, v0
    v_lshl_add_u32 v12, v12, 4, s12
    s_waitcnt lgkmcnt(0)
    ds_read_b128 v[36:39], v12 offset:6592
    s_waitcnt lgkmcnt(0)
    v_perm_b32 v44, v36, v36, s6
    v_and_b32 v48, v2, v44
    v_and_b32 v49, v3, v44
    v_and_b32 v50, v4, v44
    v_and_b32 v51, v5, v44
    s_nop 1
    v_mfma_f32_16x16x32_bf16 v[28:31], v[96:99], v[48:51], 0
    v_perm_b32 v44, v36, v36, s7
    v_and_b32 v52, v2, v44
    v_and_b32 v53, v3, v44
    v_and_b32 v54, v4, v44
    v_and_b32 v55, v5, v44
    s_nop 1
    v_mfma_f32_16x16x32_bf16 v[28:31], v[100:103], v[52:55], v[28:31]
    v_perm_b32 v44, v37, v37, s6
    v_and_b32 v56, v2, v44
    v_and_b32 v57, v3, v44
    v_and_b32 v58, v4, v44
    v_and_b32 v59, v5, v44
    s_nop 1
    v_mfma_f32_16x16x32_bf16 v[28:31], v[104:107], v[56:59], v[28:31]
    v_perm_b32 v44, v37, v37, s7
    v_and_b32 v60, v2, v44
    v_and_b32 v61, v3, v44
    v_and_b32 v62, v4, v44
    v_and_b32 v63, v5, v44
    s_nop 1
    v_mfma_f32_16x16x32_bf16 v[28:31], v[108:111], v[60:63], v[28:31]
    v_perm_b32 v44, v38, v38, s6
    v_and_b32 v48, v2, v44
    v_and_b32 v49, v3, v44
    v_and_b32 v50, v4, v44
    v_and_b32 v51, v5, v44
    s_nop 1
    v_mfma_f32_16x16x32_bf16 v[28:31], v[112:115], v[48:51], v[28:31]
    v_perm_b32 v44, v38, v38, s7
    v_and_b32 v52, v2, v44
    v_and_b32 v53, v3, v44
    v_and_b32 v54, v4, v44
    v_and_b32 v55, v5, v44
    s_nop 1
    v_mfma_f32_16x16x32_bf16 v[28:31], v[116:119], v[52:55], v[28:31]
    v_perm_b32 v44, v39, v39, s6
    v_and_b32 v56, v2, v44
    v_and_b32 v57, v3, v44
    v_and_b32 v58, v4, v44
    v_and_b32 v59, v5, v44
    s_nop 1
    v_mfma_f32_16x16x32_bf16 v[28:31], v[120:123], v[56:59], v[28:31]
    v_perm_b32 v44, v39, v39, s7
    v_and_b32 v60, v2, v44
    v_and_b32 v61, v3, v44
    v_and_b32 v62, v4, v44
    v_and_b32 v63, v5, v44
    s_nop 1
    v_mfma_f32_16x16x32_bf16 v[28:31], v[124:127], v[60:63], v[28:31]
    s_lshl_b32 s12, s5, 15
    s_lshl_b32 s13, s4, 2
    s_add_u32 s13, s13, s3
    s_lshl_b32 s13, s13, 9
    s_add_u32 s12, s12, s13
    s_add_u32 s12, s12, 917504
    v_lshlrev_b32 v12, 3, v0
    v_mov_b32 v45, s79
    s_nop 0
    v_cndmask_b32 v44, v28, v31, s[14:15]
    v_cndmask_b32 v46, v30, v29, s[14:15]
    s_nop 1
    v_add_f32_dpp v44, v46, v44 row_ror:8 row_mask:0xf bank_mask:0xf
    buffer_store_dwordx2 v[44:45], v12, s[52:55], s12 offen sc1
    s_endpgm
L_final:
    s_lshl_b32 s68, s4, 15
    s_add_u32 s68, s68, 917504
    s_add_u32 s69, s68, 4096
    s_add_u32 s70, s68, 8192
    s_add_u32 s71, s68, 12288
    s_add_u32 s72, s68, 16384
    s_add_u32 s73, s68, 20480
    s_add_u32 s74, s68, 24576
    s_add_u32 s75, s68, 28672
    v_and_b32 v12, 31, v0
    v_lshlrev_b32 v13, 2, v12
    s_lshl_b32 s13, s4, 7
    buffer_load_dword v14, v13, s[60:63], s13 offen
    v_lshlrev_b32 v12, 3, v12
    ds_read_b64 v[16:17], v12 offset:1920
    s_mov_b32 s12, 262144
L_poll2:
    buffer_load_dwordx4 v[128:131], v10, s[52:55], s68 offen offset:0 sc1
    buffer_load_dwordx4 v[132:135], v10, s[52:55], s68 offen offset:1024 sc1
    buffer_load_dwordx4 v[136:139], v10, s[52:55], s68 offen offset:2048 sc1
    buffer_load_dwordx4 v[140:143], v10, s[52:55], s68 offen offset:3072 sc1
    buffer_load_dwordx4 v[144:147], v10, s[52:55], s69 offen offset:0 sc1
    buffer_load_dwordx4 v[148:151], v10, s[52:55], s69 offen offset:1024 sc1
    buffer_load_dwordx4 v[152:155], v10, s[52:55], s69 offen offset:2048 sc1
    buffer_load_dwordx4 v[156:159], v10, s[52:55], s69 offen offset:3072 sc1
    buffer_load_dwordx4 v[160:163], v10, s[52:55], s70 offen offset:0 sc1
    buffer_load_dwordx4 v[164:167], v10, s[52:55], s70 offen offset:1024 sc1
    buffer_load_dwordx4 v[168:171], v10, s[52:55], s70 offen offset:2048 sc1
    buffer_load_dwordx4 v[172:175], v10, s[52:55], s70 offen offset:3072 sc1
    buffer_load_dwordx4 v[176:179], v10, s[52:55], s71 offen offset:0 sc1
    buffer_load_dwordx4 v[180:183], v10, s[52:55], s71 offen offset:1024 sc1
    buffer_load_dwordx4 v[184:187], v10, s[52:55], s71 offen offset:2048 sc1
    buffer_load_dwordx4 v[188:191], v10, s[52:55], s71 offen offset:3072 sc1
    buffer_load_dwordx4 v[192:195], v10, s[52:55], s72 offen offset:0 sc1
    buffer_load_dwordx4 v[196:199], v10, s[52:55], s72 offen offset:1024 sc1
    buffer_load_dwordx4 v[200:203], v10, s[52:55], s72 offen offset:2048 sc1
    buffer_load_dwordx4 v[204:207], v10, s[52:55], s72 offen offset:3072 sc1
    buffer_load_dwordx4 v[208:211], v10, s[52:55], s73 offen offset:0 sc1
    buffer_load_dwordx4 v[212:215], v10, s[52:55], s73 offen offset:1024 sc1
    buffer_load_dwordx4 v[216:219], v10, s[52:55], s73 offen offset:2048 sc1
    buffer_load_dwordx4 v[220:223], v10, s[52:55], s73 offen offset:3072 sc1
    buffer_load_dwordx4 v[224:227], v10, s[52:55], s74 offen offset:0 sc1
    buffer_load_dwordx4 v[228:231], v10, s[52:55], s74 offen offset:1024 sc1
    buffer_load_dwordx4 v[232:235], v10, s[52:55], s74 offen offset:2048 sc1
    buffer_load_dwordx4 v[236:239], v10, s[52:55], s74 offen offset:3072 sc1
    buffer_load_dwordx4 v[240:243], v10, s[52:55], s75 offen offset:0 sc1
    buffer_load_dwordx4 v[244:247], v10, s[52:55], s75 offen offset:1024 sc1
    buffer_load_dwordx4 v[248:251], v10, s[52:55], s75 offen offset:2048 sc1
    buffer_load_dwordx4 v[252:255], v10, s[52:55], s75 offen offset:3072 sc1
    s_waitcnt vmcnt(0) lgkmcnt(0)
    v_max_u32 v44, v129, v131
    v_min_u32 v45, v129, v131
    v_max3_u32 v44, v44, v133, v135
    v_min3_u32 v45, v45, v133, v135
    v_max3_u32 v44, v44, v137, v139
    v_min3_u32 v45, v45, v137, v139
    v_max3_u32 v44, v44, v141, v143
    v_min3_u32 v45, v45, v141, v143
    v_max3_u32 v44, v44, v145, v147
    v_min3_u32 v45, v45, v145, v147
    v_max3_u32 v44, v44, v149, v151
    v_min3_u32 v45, v45, v149, v151
    v_max3_u32 v44, v44, v153, v155
    v_min3_u32 v45, v45, v153, v155
    v_max3_u32 v44, v44, v157, v159
    v_min3_u32 v45, v45, v157, v159
    v_max3_u32 v44, v44, v161, v163
    v_min3_u32 v45, v45, v161, v163
    v_max3_u32 v44, v44, v165, v167
    v_min3_u32 v45, v45, v165, v167
    v_max3_u32 v44, v44, v169, v171
    v_min3_u32 v45, v45, v169, v171
    v_max3_u32 v44, v44, v173, v175
    v_min3_u32 v45, v45, v173, v175
    v_max3_u32 v44, v44, v177, v179
    v_min3_u32 v45, v45, v177, v179
    v_max3_u32 v44, v44, v181, v183
    v_min3_u32 v45, v45, v181, v183
    v_max3_u32 v44, v44, v185, v187
    v_min3_u32 v45, v45, v185, v187
    v_max3_u32 v44, v44, v189, v191
    v_min3_u32 v45, v45, v189, v191
    v_max3_u32 v44, v44, v193, v195
    v_min3_u32 v45, v45, v193, v195
    v_max3_u32 v44, v44, v197, v199
    v_min3_u32 v45, v45, v197, v199
    v_max3_u32 v44, v44, v201, v203
    v_min3_u32 v45, v45, v201, v203
    v_max3_u32 v44, v44, v205, v207
    v_min3_u32 v45, v45, v205, v207
    v_max3_u32 v44, v44, v209, v211
    v_min3_u32 v45, v45, v209, v211
    v_max3_u32 v44, v44, v213, v215
    v_min3_u32 v45, v45, v213, v215
    v_max3_u32 v44, v44, v217, v219
    v_min3_u32 v45, v45, v217, v219
    v_max3_u32 v44, v44, v221, v223
    v_min3_u32 v45, v45, v221, v223
    v_max3_u32 v44, v44, v225, v227
    v_min3_u32 v45, v45, v225, v227
    v_max3_u32 v44, v44, v229, v231
    v_min3_u32 v45, v45, v229, v231
    v_max3_u32 v44, v44, v233, v235
    v_min3_u32 v45, v45, v233, v235
    v_max3_u32 v44, v44, v237, v239
    v_min3_u32 v45, v45, v237, v239
    v_max3_u32 v44, v44, v241, v243
    v_min3_u32 v45, v45, v241, v243
    v_max3_u32 v44, v44, v245, v247
    v_min3_u32 v45, v45, v245, v247
    v_max3_u32 v44, v44, v249, v251
    v_min3_u32 v45, v45, v249, v251
    v_max3_u32 v44, v44, v253, v255
    v_min3_u32 v45, v45, v253, v255
    v_xor_b32 v44, s79, v44
    v_xor_b32 v45, s79, v45
    v_or_b32 v44, v44, v45
    v_cmp_ne_u32 vcc, 0, v44
    s_sub_u32 s12, s12, 1
    s_cmp_eq_u32 s12, 0
    s_cbranch_scc1 L_poll2_done
    s_cbranch_vccnz L_poll2
L_poll2_done:
    v_add_f32 v128, v128, v132
    v_add_f32 v130, v130, v134
    v_add_f32 v128, v128, v136
    v_add_f32 v130, v130, v138
    v_add_f32 v128, v128, v140
    v_add_f32 v130, v130, v142
    v_add_f32 v128, v128, v144
    v_add_f32 v130, v130, v146
    v_add_f32 v128, v128, v148
    v_add_f32 v130, v130, v150
    v_add_f32 v128, v128, v152
    v_add_f32 v130, v130, v154
    v_add_f32 v128, v128, v156
    v_add_f32 v130, v130, v158
    v_add_f32 v128, v128, v160
    v_add_f32 v130, v130, v162
    v_add_f32 v128, v128, v164
    v_add_f32 v130, v130, v166
    v_add_f32 v128, v128, v168
    v_add_f32 v130, v130, v170
    v_add_f32 v128, v128, v172
    v_add_f32 v130, v130, v174
    v_add_f32 v128, v128, v176
    v_add_f32 v130, v130, v178
    v_add_f32 v128, v128, v180
    v_add_f32 v130, v130, v182
    v_add_f32 v128, v128, v184
    v_add_f32 v130, v130, v186
    v_add_f32 v128, v128, v188
    v_add_f32 v130, v130, v190
    v_add_f32 v128, v128, v192
    v_add_f32 v130, v130, v194
    v_add_f32 v128, v128, v196
    v_add_f32 v130, v130, v198
    v_add_f32 v128, v128, v200
    v_add_f32 v130, v130, v202
    v_add_f32 v128, v128, v204
    v_add_f32 v130, v130, v206
    v_add_f32 v128, v128, v208
    v_add_f32 v130, v130, v210
    v_add_f32 v128, v128, v212
    v_add_f32 v130, v130, v214
    v_add_f32 v128, v128, v216
    v_add_f32 v130, v130, v218
    v_add_f32 v128, v128, v220
    v_add_f32 v130, v130, v222
    v_add_f32 v128, v128, v224
    v_add_f32 v130, v130, v226
    v_add_f32 v128, v128, v228
    v_add_f32 v130, v130, v230
    v_add_f32 v128, v128, v232
    v_add_f32 v130, v130, v234
    v_add_f32 v128, v128, v236
    v_add_f32 v130, v130, v238
    v_add_f32 v128, v128, v240
    v_add_f32 v130, v130, v242
    v_add_f32 v128, v128, v244
    v_add_f32 v130, v130, v246
    v_add_f32 v128, v128, v248
    v_add_f32 v130, v130, v250
    v_add_f32 v128, v128, v252
    v_add_f32 v130, v130, v254
    v_mov_b32 v44, v128
    s_nop 1
    v_permlane32_swap_b32 v128, v44
    s_nop 1
    v_add_f32 v128, v128, v44
    v_mov_b32 v44, v130
    s_nop 1
    v_permlane32_swap_b32 v130, v44
    s_nop 1
    v_add_f32 v130, v130, v44
    v_cvt_pk_bf16_f32 v128, v128, v128
    v_lshlrev_b32 v128, 16, v128
    v_mul_f32 v128, v128, v16
    v_cvt_pk_bf16_f32 v128, v128, v128
    v_lshlrev_b32 v128, 16, v128
    v_cvt_pk_bf16_f32 v130, v130, v130
    v_lshlrev_b32 v130, 16, v130
    v_mul_f32 v130, v130, v17
    v_cvt_pk_bf16_f32 v130, v130, v130
    v_lshlrev_b32 v130, 16, v130
    v_lshlrev_b32 v20, 16, v14
    v_and_b32 v21, 0xffff0000, v14
    v_add_f32 v20, v20, v128
    v_add_f32 v21, v21, v130
    v_cvt_pk_bf16_f32 v20, v20, v21
    s_mov_b64 exec, 0xffffffff
    buffer_store_dword v20, v13, s[56:59], s13 offen
    s_cmp_lg_u32 s4, 0
    s_cbranch_scc1 L_end
    s_add_u32 s80, s80, 1
    v_mov_b32 v21, s80
    v_mov_b32 v22, 0
    s_mov_b64 exec, 1
    buffer_store_dword v21, v22, s[52:55], 0 offen sc1
    s_endpgm
L_aux:
    s_setprio 2
    s_cmp_eq_u32 s3, 5
    s_cbranch_scc1 L_qcons
    s_cmp_ge_u32 s5, 8
    s_cbranch_scc1 L_ffn0
    s_mov_b32 s40, s22
    s_and_b32 s41, s23, 0xffff
    s_mov_b32 s42, 4718592
    s_mov_b32 s43, 0x20000
    v_lshlrev_b32 v9, 4, v0
    v_lshlrev_b32 v10, 2, v0
    buffer_load_dwordx4 v[12:15], v9, s[60:63], 0 offen
    buffer_load_dword v16, v10, s[60:63], 0 offen offset:1024
    v_and_b32 v11, 1, v0
    v_lshl_add_u32 v11, v6, 1, v11
    s_mov_b32 s10, 73728
    v_mul_lo_u32 v11, v11, s10
    v_bfe_u32 v17, v0, 1, 3
    v_lshl_add_u32 v11, v17, 4, v11
    s_mul_i32 s9, s5, 589824
    s_lshl_b32 s10, s4, 9
    s_add_u32 s9, s9, s10
    buffer_load_dwordx4 v[100:103], v11, s[40:43], s9 offen offset:0 nt
    buffer_load_dwordx4 v[104:107], v11, s[40:43], s9 offen offset:128 nt
    buffer_load_dwordx4 v[108:111], v11, s[40:43], s9 offen offset:256 nt
    buffer_load_dwordx4 v[112:115], v11, s[40:43], s9 offen offset:384 nt
    s_add_u32 s9, s9, 8192
    buffer_load_dwordx4 v[116:119], v11, s[40:43], s9 offen offset:0 nt
    buffer_load_dwordx4 v[120:123], v11, s[40:43], s9 offen offset:128 nt
    buffer_load_dwordx4 v[124:127], v11, s[40:43], s9 offen offset:256 nt
    buffer_load_dwordx4 v[128:131], v11, s[40:43], s9 offen offset:384 nt
    s_add_u32 s9, s9, 8192
    buffer_load_dwordx4 v[132:135], v11, s[40:43], s9 offen offset:0 nt
    buffer_load_dwordx4 v[136:139], v11, s[40:43], s9 offen offset:128 nt
    buffer_load_dwordx4 v[140:143], v11, s[40:43], s9 offen offset:256 nt
    buffer_load_dwordx4 v[144:147], v11, s[40:43], s9 offen offset:384 nt
    s_add_u32 s9, s9, 8192
    buffer_load_dwordx4 v[148:151], v11, s[40:43], s9 offen offset:0 nt
    buffer_load_dwordx4 v[152:155], v11, s[40:43], s9 offen offset:128 nt
    buffer_load_dwordx4 v[156:159], v11, s[40:43], s9 offen offset:256 nt
    buffer_load_dwordx4 v[160:163], v11, s[40:43], s9 offen offset:384 nt
    s_add_u32 s9, s9, 8192
    buffer_load_dwordx4 v[164:167], v11, s[40:43], s9 offen offset:0 nt
    buffer_load_dwordx4 v[168:171], v11, s[40:43], s9 offen offset:128 nt
    buffer_load_dwordx4 v[172:175], v11, s[40:43], s9 offen offset:256 nt
    buffer_load_dwordx4 v[176:179], v11, s[40:43], s9 offen offset:384 nt
    s_add_u32 s9, s9, 8192
    buffer_load_dwordx4 v[180:183], v11, s[40:43], s9 offen offset:0 nt
    buffer_load_dwordx4 v[184:187], v11, s[40:43], s9 offen offset:128 nt
    buffer_load_dwordx4 v[188:191], v11, s[40:43], s9 offen offset:256 nt
    buffer_load_dwordx4 v[192:195], v11, s[40:43], s9 offen offset:384 nt
    s_add_u32 s9, s9, 8192
    buffer_load_dwordx4 v[196:199], v11, s[40:43], s9 offen offset:0 nt
    buffer_load_dwordx4 v[200:203], v11, s[40:43], s9 offen offset:128 nt
    buffer_load_dwordx4 v[204:207], v11, s[40:43], s9 offen offset:256 nt
    buffer_load_dwordx4 v[208:211], v11, s[40:43], s9 offen offset:384 nt
    s_add_u32 s9, s9, 8192
    buffer_load_dwordx4 v[212:215], v11, s[40:43], s9 offen offset:0 nt
    buffer_load_dwordx4 v[216:219], v11, s[40:43], s9 offen offset:128 nt
    buffer_load_dwordx4 v[220:223], v11, s[40:43], s9 offen offset:256 nt
    buffer_load_dwordx4 v[224:227], v11, s[40:43], s9 offen offset:384 nt
    s_add_u32 s9, s9, 8192
    buffer_load_dwordx4 v[228:231], v11, s[40:43], s9 offen offset:0 nt
    buffer_load_dwordx4 v[232:235], v11, s[40:43], s9 offen offset:128 nt
    buffer_load_dwordx4 v[236:239], v11, s[40:43], s9 offen offset:256 nt
    buffer_load_dwordx4 v[240:243], v11, s[40:43], s9 offen offset:384 nt
    s_add_u32 s9, s9, 8192
    s_lshl_b32 s9, s4, 8
    s_add_u32 s9, s9, 4096
    v_mov_b32 v33, 3712
    v_mov_b32 v34, 0
    s_cmp_eq_u32 s5, 0
    s_cselect_b64 exec, 1, 0
    s_cbranch_execz L_noct
    buffer_store_dword v33, v34, s[52:55], s9 offen sc1
L_noct:
    s_mov_b64 exec, -1
    s_waitcnt vmcnt(36)
    v_lshlrev_b32 v18, 16, v12
    v_and_b32 v19, 0xffff0000, v12
    v_lshlrev_b32 v20, 16, v13
    v_and_b32 v21, 0xffff0000, v13
    v_lshlrev_b32 v22, 16, v14
    v_and_b32 v23, 0xffff0000, v14
    v_lshlrev_b32 v24, 16, v15
    v_and_b32 v25, 0xffff0000, v15
    v_lshlrev_b32 v26, 16, v16
    v_and_b32 v27, 0xffff0000, v16
    v_add_f32 v28, v18, v19
    v_add_f32 v28, v28, v20
    v_add_f32 v28, v28, v21
    v_add_f32 v28, v28, v22
    v_add_f32 v28, v28, v23
    v_add_f32 v28, v28, v24
    v_add_f32 v28, v28, v25
    v_add_f32 v28, v28, v26
    v_add_f32 v28, v28, v27
    s_nop 1
    v_add_f32_dpp v28, v28, v28 quad_perm:[1,0,3,2] row_mask:0xf bank_mask:0xf
    s_nop 1
    v_add_f32_dpp v28, v28, v28 quad_perm:[2,3,0,1] row_mask:0xf bank_mask:0xf
    s_nop 1
    v_add_f32_dpp v28, v28, v28 row_half_mirror row_mask:0xf bank_mask:0xf
    s_nop 1
    v_add_f32_dpp v28, v28, v28 row_mirror row_mask:0xf bank_mask:0xf
    v_mov_b32 v29, v28
    s_nop 1
    v_permlane16_swap_b32 v28, v29
    s_nop 1
    v_add_f32 v28, v28, v29
    v_mov_b32 v29, v28
    s_nop 1
    v_permlane32_swap_b32 v28, v29
    s_nop 1
    v_add_f32 v28, v28, v29
    v_mul_f32 v28, 0x3ae38e39, v28
    v_cmp_gt_u32 vcc, 32, v0
    v_sub_f32 v29, v18, v28
    v_mul_f32 v30, v29, v29
    v_sub_f32 v29, v19, v28
    v_fmac_f32 v30, v29, v29
    v_sub_f32 v29, v20, v28
    v_fmac_f32 v30, v29, v29
    v_sub_f32 v29, v21, v28
    v_fmac_f32 v30, v29, v29
    v_sub_f32 v29, v22, v28
    v_fmac_f32 v30, v29, v29
    v_sub_f32 v29, v23, v28
    v_fmac_f32 v30, v29, v29
    v_sub_f32 v29, v24, v28
    v_fmac_f32 v30, v29, v29
    v_sub_f32 v29, v25, v28
    v_fmac_f32 v30, v29, v29
    v_sub_f32 v29, v26, v28
    v_cndmask_b32 v29, 0, v29, vcc
    v_fmac_f32 v30, v29, v29
    v_sub_f32 v29, v27, v28
    v_cndmask_b32 v29, 0, v29, vcc
    v_fmac_f32 v30, v29, v29
    s_nop 1
    v_add_f32_dpp v30, v30, v30 quad_perm:[1,0,3,2] row_mask:0xf bank_mask:0xf
    s_nop 1
    v_add_f32_dpp v30, v30, v30 quad_perm:[2,3,0,1] row_mask:0xf bank_mask:0xf
    s_nop 1
    v_add_f32_dpp v30, v30, v30 row_half_mirror row_mask:0xf bank_mask:0xf
    s_nop 1
    v_add_f32_dpp v30, v30, v30 row_mirror row_mask:0xf bank_mask:0xf
    v_mov_b32 v29, v30
    s_nop 1
    v_permlane16_swap_b32 v30, v29
    s_nop 1
    v_add_f32 v30, v30, v29
    v_mov_b32 v29, v30
    s_nop 1
    v_permlane32_swap_b32 v30, v29
    s_nop 1
    v_add_f32 v30, v30, v29
    v_mul_f32 v30, 0x3ae38e39, v30
    v_cvt_pk_bf16_f32 v30, v30, v30
    v_lshlrev_b32 v30, 16, v30
    v_cvt_pk_bf16_f32 v28, v28, v28
    v_lshlrev_b32 v28, 16, v28
    v_add_f32 v30, 0x3727c5ac, v30
    v_cvt_pk_bf16_f32 v30, v30, v30
    v_lshlrev_b32 v30, 16, v30
    v_sqrt_f32 v30, v30
    s_nop 0
    v_cvt_pk_bf16_f32 v30, v30, v30
    v_lshlrev_b32 v30, 16, v30
    v_rcp_f32 v29, v30
    v_sub_f32 v18, v18, v28
    v_cvt_pk_bf16_f32 v18, v18, v18
    v_lshlrev_b32 v18, 16, v18
    v_sub_f32 v19, v19, v28
    v_cvt_pk_bf16_f32 v19, v19, v19
    v_lshlrev_b32 v19, 16, v19
    v_sub_f32 v20, v20, v28
    v_cvt_pk_bf16_f32 v20, v20, v20
    v_lshlrev_b32 v20, 16, v20
    v_sub_f32 v21, v21, v28
    v_cvt_pk_bf16_f32 v21, v21, v21
    v_lshlrev_b32 v21, 16, v21
    v_sub_f32 v22, v22, v28
    v_cvt_pk_bf16_f32 v22, v22, v22
    v_lshlrev_b32 v22, 16, v22
    v_sub_f32 v23, v23, v28
    v_cvt_pk_bf16_f32 v23, v23, v23
    v_lshlrev_b32 v23, 16, v23
    v_sub_f32 v24, v24, v28
    v_cvt_pk_bf16_f32 v24, v24, v24
    v_lshlrev_b32 v24, 16, v24
    v_sub_f32 v25, v25, v28
    v_cvt_pk_bf16_f32 v25, v25, v25
    v_lshlrev_b32 v25, 16, v25
    v_sub_f32 v26, v26, v28
    v_cvt_pk_bf16_f32 v26, v26, v26
    v_lshlrev_b32 v26, 16, v26
    v_sub_f32 v27, v27, v28
    v_cvt_pk_bf16_f32 v27, v27, v27
    v_lshlrev_b32 v27, 16, v27
    v_mul_f32 v31, v18, v29
    v_fma_f32 v32, -v31, v30, v18
    v_fma_f32 v18, v32, v29, v31
    v_mul_f32 v31, v19, v29
    v_fma_f32 v32, -v31, v30, v19
    v_fma_f32 v19, v32, v29, v31
    v_mul_f32 v31, v20, v29
    v_fma_f32 v32, -v31, v30, v20
    v_fma_f32 v20, v32, v29, v31
    v_mul_f32 v31, v21, v29
    v_fma_f32 v32, -v31, v30, v21
    v_fma_f32 v21, v32, v29, v31
    v_mul_f32 v31, v22, v29
    v_fma_f32 v32, -v31, v30, v22
    v_fma_f32 v22, v32, v29, v31
    v_mul_f32 v31, v23, v29
    v_fma_f32 v32, -v31, v30, v23
    v_fma_f32 v23, v32, v29, v31
    v_mul_f32 v31, v24, v29
    v_fma_f32 v32, -v31, v30, v24
    v_fma_f32 v24, v32, v29, v31
    v_mul_f32 v31, v25, v29
    v_fma_f32 v32, -v31, v30, v25
    v_fma_f32 v25, v32, v29, v31
    v_mul_f32 v31, v26, v29
    v_fma_f32 v32, -v31, v30, v26
    v_fma_f32 v26, v32, v29, v31
    v_mul_f32 v31, v27, v29
    v_fma_f32 v32, -v31, v30, v27
    v_fma_f32 v27, v32, v29, v31
    v_cvt_pk_bf16_f32 v12, v18, v19
    v_cvt_pk_bf16_f32 v13, v20, v21
    v_cvt_pk_bf16_f32 v14, v22, v23
    v_cvt_pk_bf16_f32 v15, v24, v25
    v_cvt_pk_bf16_f32 v16, v26, v27
    ds_write_b128 v9, v[12:15] offset:0
    ds_write_b32 v10, v16 offset:1024
    s_waitcnt lgkmcnt(0)
    s_mul_i32 s10, s5, 144
    v_lshrrev_b32 v17, 3, v0
    v_mul_u32_u24 v17, 18, v17
    v_add_u32 v17, s10, v17
    ds_read_u16 v18, v17 offset:0
    ds_read_u16 v19, v17 offset:2
    ds_read_u16 v20, v17 offset:4
    ds_read_u16 v21, v17 offset:6
    ds_read_u16 v22, v17 offset:8
    ds_read_u16 v23, v17 offset:10
    ds_read_u16 v24, v17 offset:12
    ds_read_u16 v25, v17 offset:14
    ds_read_u16 v26, v17 offset:16
    s_waitcnt lgkmcnt(0)
    s_mul_i32 s79, s80, 0x9e3779b1
    s_add_u32 s79, s79, 0x7f4a7c15
    v_perm_b32 v9, v18, v18, s6
    v_and_b32 v56, v2, v9
    v_and_b32 v57, v3, v9
    v_and_b32 v58, v4, v9
    v_and_b32 v59, v5, v9
    s_waitcnt vmcnt(32)
    s_nop 0
    v_mfma_f32_16x16x32_bf16 v[40:43], v[100:103], v[56:59], 0
    v_mfma_f32_16x16x32_bf16 v[44:47], v[104:107], v[56:59], 0
    v_mfma_f32_16x16x32_bf16 v[48:51], v[108:111], v[56:59], 0
    v_mfma_f32_16x16x32_bf16 v[52:55], v[112:115], v[56:59], 0
    v_perm_b32 v9, v19, v19, s6
    v_and_b32 v60, v2, v9
    v_and_b32 v61, v3, v9
    v_and_b32 v62, v4, v9
    v_and_b32 v63, v5, v9
    s_waitcnt vmcnt(28)
    s_nop 0
    v_mfma_f32_16x16x32_bf16 v[40:43], v[116:119], v[60:63], v[40:43]
    v_mfma_f32_16x16x32_bf16 v[44:47], v[120:123], v[60:63], v[44:47]
    v_mfma_f32_16x16x32_bf16 v[48:51], v[124:127], v[60:63], v[48:51]
    v_mfma_f32_16x16x32_bf16 v[52:55], v[128:131], v[60:63], v[52:55]
    v_perm_b32 v9, v20, v20, s6
    v_and_b32 v56, v2, v9
    v_and_b32 v57, v3, v9
    v_and_b32 v58, v4, v9
    v_and_b32 v59, v5, v9
    s_waitcnt vmcnt(24)
    s_nop 0
    v_mfma_f32_16x16x32_bf16 v[40:43], v[132:135], v[56:59], v[40:43]
    v_mfma_f32_16x16x32_bf16 v[44:47], v[136:139], v[56:59], v[44:47]
    v_mfma_f32_16x16x32_bf16 v[48:51], v[140:143], v[56:59], v[48:51]
    v_mfma_f32_16x16x32_bf16 v[52:55], v[144:147], v[56:59], v[52:55]
    v_perm_b32 v9, v21, v21, s6
    v_and_b32 v60, v2, v9
    v_and_b32 v61, v3, v9
    v_and_b32 v62, v4, v9
    v_and_b32 v63, v5, v9
    s_waitcnt vmcnt(20)
    s_nop 0
    v_mfma_f32_16x16x32_bf16 v[40:43], v[148:151], v[60:63], v[40:43]
    v_mfma_f32_16x16x32_bf16 v[44:47], v[152:155], v[60:63], v[44:47]
    v_mfma_f32_16x16x32_bf16 v[48:51], v[156:159], v[60:63], v[48:51]
    v_mfma_f32_16x16x32_bf16 v[52:55], v[160:163], v[60:63], v[52:55]
    v_perm_b32 v9, v22, v22, s6
    v_and_b32 v56, v2, v9
    v_and_b32 v57, v3, v9
    v_and_b32 v58, v4, v9
    v_and_b32 v59, v5, v9
    s_waitcnt vmcnt(16)
    s_nop 0
    v_mfma_f32_16x16x32_bf16 v[40:43], v[164:167], v[56:59], v[40:43]
    v_mfma_f32_16x16x32_bf16 v[44:47], v[168:171], v[56:59], v[44:47]
    v_mfma_f32_16x16x32_bf16 v[48:51], v[172:175], v[56:59], v[48:51]
    v_mfma_f32_16x16x32_bf16 v[52:55], v[176:179], v[56:59], v[52:55]
    v_perm_b32 v9, v23, v23, s6
    v_and_b32 v60, v2, v9
    v_and_b32 v61, v3, v9
    v_and_b32 v62, v4, v9
    v_and_b32 v63, v5, v9
    s_waitcnt vmcnt(12)
    s_nop 0
    v_mfma_f32_16x16x32_bf16 v[40:43], v[180:183], v[60:63], v[40:43]
    v_mfma_f32_16x16x32_bf16 v[44:47], v[184:187], v[60:63], v[44:47]
    v_mfma_f32_16x16x32_bf16 v[48:51], v[188:191], v[60:63], v[48:51]
    v_mfma_f32_16x16x32_bf16 v[52:55], v[192:195], v[60:63], v[52:55]
    v_perm_b32 v9, v24, v24, s6
    v_and_b32 v56, v2, v9
    v_and_b32 v57, v3, v9
    v_and_b32 v58, v4, v9
    v_and_b32 v59, v5, v9
    s_waitcnt vmcnt(8)
    s_nop 0
    v_mfma_f32_16x16x32_bf16 v[40:43], v[196:199], v[56:59], v[40:43]
    v_mfma_f32_16x16x32_bf16 v[44:47], v[200:203], v[56:59], v[44:47]
    v_mfma_f32_16x16x32_bf16 v[48:51], v[204:207], v[56:59], v[48:51]
    v_mfma_f32_16x16x32_bf16 v[52:55], v[208:211], v[56:59], v[52:55]
    v_perm_b32 v9, v25, v25, s6
    v_and_b32 v60, v2, v9
    v_and_b32 v61, v3, v9
    v_and_b32 v62, v4, v9
    v_and_b32 v63, v5, v9
    s_waitcnt vmcnt(4)
    s_nop 0
    v_mfma_f32_16x16x32_bf16 v[40:43], v[212:215], v[60:63], v[40:43]
    v_mfma_f32_16x16x32_bf16 v[44:47], v[216:219], v[60:63], v[44:47]
    v_mfma_f32_16x16x32_bf16 v[48:51], v[220:223], v[60:63], v[48:51]
    v_mfma_f32_16x16x32_bf16 v[52:55], v[224:227], v[60:63], v[52:55]
    v_perm_b32 v9, v26, v26, s6
    v_and_b32 v56, v2, v9
    v_and_b32 v57, v3, v9
    v_and_b32 v58, v4, v9
    v_and_b32 v59, v5, v9
    s_waitcnt vmcnt(0)
    s_nop 0
    v_mfma_f32_16x16x32_bf16 v[40:43], v[228:231], v[56:59], v[40:43]
    v_mfma_f32_16x16x32_bf16 v[44:47], v[232:235], v[56:59], v[44:47]
    v_mfma_f32_16x16x32_bf16 v[48:51], v[236:239], v[56:59], v[48:51]
    v_mfma_f32_16x16x32_bf16 v[52:55], v[240:243], v[56:59], v[52:55]
    s_lshl_b32 s9, s4, 14
    s_lshl_b32 s10, s5, 11
    s_add_u32 s9, s9, s10
    s_add_u32 s9, s9, 65536
    v_lshlrev_b32 v10, 3, v0
    v_mov_b32 v21, s79
    v_mov_b32 v23, s79
    v_mov_b32 v25, s79
    v_mov_b32 v27, s79
    v_cndmask_b32 v20, v40, v43, s[14:15]
    v_cndmask_b32 v9, v42, v41, s[14:15]
    s_nop 1
    v_add_f32_dpp v20, v9, v20 row_ror:8 row_mask:0xf bank_mask:0xf
    buffer_store_dwordx2 v[20:21], v10, s[52:55], s9 offen offset:0 sc1
    v_cndmask_b32 v22, v44, v47, s[14:15]
    v_cndmask_b32 v9, v46, v45, s[14:15]
    s_nop 1
    v_add_f32_dpp v22, v9, v22 row_ror:8 row_mask:0xf bank_mask:0xf
    buffer_store_dwordx2 v[22:23], v10, s[52:55], s9 offen offset:512 sc1
    v_cndmask_b32 v24, v48, v51, s[14:15]
    v_cndmask_b32 v9, v50, v49, s[14:15]
    s_nop 1
    v_add_f32_dpp v24, v9, v24 row_ror:8 row_mask:0xf bank_mask:0xf
    buffer_store_dwordx2 v[24:25], v10, s[52:55], s9 offen offset:1024 sc1
    v_cndmask_b32 v26, v52, v55, s[14:15]
    v_cndmask_b32 v9, v54, v53, s[14:15]
    s_nop 1
    v_add_f32_dpp v26, v9, v26 row_ror:8 row_mask:0xf bank_mask:0xf
    buffer_store_dwordx2 v[26:27], v10, s[52:55], s9 offen offset:1536 sc1
    s_endpgm
L_qcons:
    s_lshl_b32 s68, s4, 14
    s_add_u32 s68, s68, 65536
    s_add_u32 s69, s68, 4096
    s_add_u32 s70, s68, 8192
    s_add_u32 s71, s68, 12288
    v_lshlrev_b32 v10, 4, v0
    v_lshlrev_b32 v11, 2, v0
    s_mov_b32 s12, 262144
    s_waitcnt lgkmcnt(0)
    s_mul_i32 s79, s80, 0x9e3779b1
    s_add_u32 s79, s79, 0x7f4a7c15
    s_sleep 120
L_pollq:
    buffer_load_dwordx4 v[64:67], v10, s[52:55], s68 offen offset:0 sc1
    buffer_load_dwordx4 v[68:71], v10, s[52:55], s68 offen offset:1024 sc1
    buffer_load_dwordx4 v[72:75], v10, s[52:55], s68 offen offset:2048 sc1
    buffer_load_dwordx4 v[76:79], v10, s[52:55], s68 offen offset:3072 sc1
    buffer_load_dwordx4 v[80:83], v10, s[52:55], s69 offen offset:0 sc1
    buffer_load_dwordx4 v[84:87], v10, s[52:55], s69 offen offset:1024 sc1
    buffer_load_dwordx4 v[88:91], v10, s[52:55], s69 offen offset:2048 sc1
    buffer_load_dwordx4 v[92:95], v10, s[52:55], s69 offen offset:3072 sc1
    buffer_load_dwordx4 v[96:99], v10, s[52:55], s70 offen offset:0 sc1
    buffer_load_dwordx4 v[100:103], v10, s[52:55], s70 offen offset:1024 sc1
    buffer_load_dwordx4 v[104:107], v10, s[52:55], s70 offen offset:2048 sc1
    buffer_load_dwordx4 v[108:111], v10, s[52:55], s70 offen offset:3072 sc1
    buffer_load_dwordx4 v[112:115], v10, s[52:55], s71 offen offset:0 sc1
    buffer_load_dwordx4 v[116:119], v10, s[52:55], s71 offen offset:1024 sc1
    buffer_load_dwordx4 v[120:123], v10, s[52:55], s71 offen offset:2048 sc1
    buffer_load_dwordx4 v[124:127], v10, s[52:55], s71 offen offset:3072 sc1
    s_waitcnt vmcnt(0)
    v_max_u32 v12, v65, v67
    v_min_u32 v13, v65, v67
    v_max3_u32 v12, v12, v69, v71
    v_min3_u32 v13, v13, v69, v71
    v_max3_u32 v12, v12, v73, v75
    v_min3_u32 v13, v13, v73, v75
    v_max3_u32 v12, v12, v77, v79
    v_min3_u32 v13, v13, v77, v79
    v_max3_u32 v12, v12, v81, v83
    v_min3_u32 v13, v13, v81, v83
    v_max3_u32 v12, v12, v85, v87
    v_min3_u32 v13, v13, v85, v87
    v_max3_u32 v12, v12, v89, v91
    v_min3_u32 v13, v13, v89, v91
    v_max3_u32 v12, v12, v93, v95
    v_min3_u32 v13, v13, v93, v95
    v_max3_u32 v12, v12, v97, v99
    v_min3_u32 v13, v13, v97, v99
    v_max3_u32 v12, v12, v101, v103
    v_min3_u32 v13, v13, v101, v103
    v_max3_u32 v12, v12, v105, v107
    v_min3_u32 v13, v13, v105, v107
    v_max3_u32 v12, v12, v109, v111
    v_min3_u32 v13, v13, v109, v111
    v_max3_u32 v12, v12, v113, v115
    v_min3_u32 v13, v13, v113, v115
    v_max3_u32 v12, v12, v117, v119
    v_min3_u32 v13, v13, v117, v119
    v_max3_u32 v12, v12, v121, v123
    v_min3_u32 v13, v13, v121, v123
    v_max3_u32 v12, v12, v125, v127
    v_min3_u32 v13, v13, v125, v127
    v_xor_b32 v12, s79, v12
    v_xor_b32 v13, s79, v13
    v_or_b32 v12, v12, v13
    v_cmp_ne_u32 vcc, 0, v12
    s_sub_u32 s12, s12, 1
    s_cmp_eq_u32 s12, 0
    s_cbranch_scc1 L_pollq_done
    s_cbranch_vccnz L_pollq
L_pollq_done:
    v_add_f32 v64, v64, v72
    v_add_f32 v66, v66, v74
    v_add_f32 v68, v68, v76
    v_add_f32 v70, v70, v78
    v_add_f32 v64, v64, v80
    v_add_f32 v66, v66, v82
    v_add_f32 v68, v68, v84
    v_add_f32 v70, v70, v86
    v_add_f32 v64, v64, v88
    v_add_f32 v66, v66, v90
    v_add_f32 v68, v68, v92
    v_add_f32 v70, v70, v94
    v_add_f32 v64, v64, v96
    v_add_f32 v66, v66, v98
    v_add_f32 v68, v68, v100
    v_add_f32 v70, v70, v102
    v_add_f32 v64, v64, v104
    v_add_f32 v66, v66, v106
    v_add_f32 v68, v68, v108
    v_add_f32 v70, v70, v110
    v_add_f32 v64, v64, v112
    v_add_f32 v66, v66, v114
    v_add_f32 v68, v68, v116
    v_add_f32 v70, v70, v118
    v_add_f32 v64, v64, v120
    v_add_f32 v66, v66, v122
    v_add_f32 v68, v68, v124
    v_add_f32 v70, v70, v126
    v_cvt_pk_bf16_f32 v12, v64, v66
    v_cvt_pk_bf16_f32 v13, v68, v70
    ds_write_b32 v11, v12 offset:1280
    ds_write_b32 v11, v13 offset:1536
    s_waitcnt lgkmcnt(0)
    s_barrier
    s_cmp_lg_u32 s5, 13
    s_cbranch_scc1 L_end
    s_cmp_ge_u32 s4, 9
    s_cbranch_scc1 L_end
    s_mul_i32 s68, s4, 36864
    s_add_u32 s68, s68, 1245184
    s_add_u32 s69, s68, 4096
    s_add_u32 s70, s68, 8192
    s_add_u32 s71, s68, 12288
    s_add_u32 s72, s68, 16384
    s_add_u32 s73, s68, 20480
    s_add_u32 s74, s68, 24576
    s_add_u32 s75, s68, 28672
    s_add_u32 s76, s68, 32768
    s_mov_b32 s12, 262144
L_poll3:
    s_sleep 127
    s_sleep 127
    buffer_load_dwordx4 v[64:67], v10, s[52:55], s68 offen offset:0 sc1
    buffer_load_dwordx4 v[68:71], v10, s[52:55], s68 offen offset:1024 sc1
    buffer_load_dwordx4 v[72:75], v10, s[52:55], s68 offen offset:2048 sc1
    buffer_load_dwordx4 v[76:79], v10, s[52:55], s68 offen offset:3072 sc1
    buffer_load_dwordx4 v[80:83], v10, s[52:55], s69 offen offset:0 sc1
    buffer_load_dwordx4 v[84:87], v10, s[52:55], s69 offen offset:1024 sc1
    buffer_load_dwordx4 v[88:91], v10, s[52:55], s69 offen offset:2048 sc1
    buffer_load_dwordx4 v[92:95], v10, s[52:55], s69 offen offset:3072 sc1
    buffer_load_dwordx4 v[96:99], v10, s[52:55], s70 offen offset:0 sc1
    buffer_load_dwordx4 v[100:103], v10, s[52:55], s70 offen offset:1024 sc1
    buffer_load_dwordx4 v[104:107], v10, s[52:55], s70 offen offset:2048 sc1
    buffer_load_dwordx4 v[108:111], v10, s[52:55], s70 offen offset:3072 sc1
    buffer_load_dwordx4 v[112:115], v10, s[52:55], s71 offen offset:0 sc1
    buffer_load_dwordx4 v[116:119], v10, s[52:55], s71 offen offset:1024 sc1
    buffer_load_dwordx4 v[120:123], v10, s[52:55], s71 offen offset:2048 sc1
    buffer_load_dwordx4 v[124:127], v10, s[52:55], s71 offen offset:3072 sc1
    buffer_load_dwordx4 v[128:131], v10, s[52:55], s72 offen offset:0 sc1
    buffer_load_dwordx4 v[132:135], v10, s[52:55], s72 offen offset:1024 sc1
    buffer_load_dwordx4 v[136:139], v10, s[52:55], s72 offen offset:2048 sc1
    buffer_load_dwordx4 v[140:143], v10, s[52:55], s72 offen offset:3072 sc1
    buffer_load_dwordx4 v[144:147], v10, s[52:55], s73 offen offset:0 sc1
    buffer_load_dwordx4 v[148:151], v10, s[52:55], s73 offen offset:1024 sc1
    buffer_load_dwordx4 v[152:155], v10, s[52:55], s73 offen offset:2048 sc1
    buffer_load_dwordx4 v[156:159], v10, s[52:55], s73 offen offset:3072 sc1
    buffer_load_dwordx4 v[160:163], v10, s[52:55], s74 offen offset:0 sc1
    buffer_load_dwordx4 v[164:167], v10, s[52:55], s74 offen offset:1024 sc1
    buffer_load_dwordx4 v[168:171], v10, s[52:55], s74 offen offset:2048 sc1
    buffer_load_dwordx4 v[172:175], v10, s[52:55], s74 offen offset:3072 sc1
    buffer_load_dwordx4 v[176:179], v10, s[52:55], s75 offen offset:0 sc1
    buffer_load_dwordx4 v[180:183], v10, s[52:55], s75 offen offset:1024 sc1
    buffer_load_dwordx4 v[184:187], v10, s[52:55], s75 offen offset:2048 sc1
    buffer_load_dwordx4 v[188:191], v10, s[52:55], s75 offen offset:3072 sc1
    buffer_load_dwordx4 v[192:195], v10, s[52:55], s76 offen offset:0 sc1
    buffer_load_dwordx4 v[196:199], v10, s[52:55], s76 offen offset:1024 sc1
    buffer_load_dwordx4 v[200:203], v10, s[52:55], s76 offen offset:2048 sc1
    buffer_load_dwordx4 v[204:207], v10, s[52:55], s76 offen offset:3072 sc1
    s_waitcnt vmcnt(0)
    v_max_u32 v12, v65, v67
    v_min_u32 v13, v65, v67
    v_max3_u32 v12, v12, v69, v71
    v_min3_u32 v13, v13, v69, v71
    v_max3_u32 v12, v12, v73, v75
    v_min3_u32 v13, v13, v73, v75
    v_max3_u32 v12, v12, v77, v79
    v_min3_u32 v13, v13, v77, v79
    v_max3_u32 v12, v12, v81, v83
    v_min3_u32 v13, v13, v81, v83
    v_max3_u32 v12, v12, v85, v87
    v_min3_u32 v13, v13, v85, v87
    v_max3_u32 v12, v12, v89, v91
    v_min3_u32 v13, v13, v89, v91
    v_max3_u32 v12, v12, v93, v95
    v_min3_u32 v13, v13, v93, v95
    v_max3_u32 v12, v12, v97, v99
    v_min3_u32 v13, v13, v97, v99
    v_max3_u32 v12, v12, v101, v103
    v_min3_u32 v13, v13, v101, v103
    v_max3_u32 v12, v12, v105, v107
    v_min3_u32 v13, v13, v105, v107
    v_max3_u32 v12, v12, v109, v111
    v_min3_u32 v13, v13, v109, v111
    v_max3_u32 v12, v12, v113, v115
    v_min3_u32 v13, v13, v113, v115
    v_max3_u32 v12, v12, v117, v119
    v_min3_u32 v13, v13, v117, v119
    v_max3_u32 v12, v12, v121, v123
    v_min3_u32 v13, v13, v121, v123
    v_max3_u32 v12, v12, v125, v127
    v_min3_u32 v13, v13, v125, v127
    v_max3_u32 v12, v12, v129, v131
    v_min3_u32 v13, v13, v129, v131
    v_max3_u32 v12, v12, v133, v135
    v_min3_u32 v13, v13, v133, v135
    v_max3_u32 v12, v12, v137, v139
    v_min3_u32 v13, v13, v137, v139
    v_max3_u32 v12, v12, v141, v143
    v_min3_u32 v13, v13, v141, v143
    v_max3_u32 v12, v12, v145, v147
    v_min3_u32 v13, v13, v145, v147
    v_max3_u32 v12, v12, v149, v151
    v_min3_u32 v13, v13, v149, v151
    v_max3_u32 v12, v12, v153, v155
    v_min3_u32 v13, v13, v153, v155
    v_max3_u32 v12, v12, v157, v159
    v_min3_u32 v13, v13, v157, v159
    v_max3_u32 v12, v12, v161, v163
    v_min3_u32 v13, v13, v161, v163
    v_max3_u32 v12, v12, v165, v167
    v_min3_u32 v13, v13, v165, v167
    v_max3_u32 v12, v12, v169, v171
    v_min3_u32 v13, v13, v169, v171
    v_max3_u32 v12, v12, v173, v175
    v_min3_u32 v13, v13, v173, v175
    v_max3_u32 v12, v12, v177, v179
    v_min3_u32 v13, v13, v177, v179
    v_max3_u32 v12, v12, v181, v183
    v_min3_u32 v13, v13, v181, v183
    v_max3_u32 v12, v12, v185, v187
    v_min3_u32 v13, v13, v185, v187
    v_max3_u32 v12, v12, v189, v191
    v_min3_u32 v13, v13, v189, v191
    v_max3_u32 v12, v12, v193, v195
    v_min3_u32 v13, v13, v193, v195
    v_max3_u32 v12, v12, v197, v199
    v_min3_u32 v13, v13, v197, v199
    v_max3_u32 v12, v12, v201, v203
    v_min3_u32 v13, v13, v201, v203
    v_max3_u32 v12, v12, v205, v207
    v_min3_u32 v13, v13, v205, v207
    v_xor_b32 v12, s79, v12
    v_xor_b32 v13, s79, v13
    v_or_b32 v12, v12, v13
    v_cmp_ne_u32 vcc, 0, v12
    s_sub_u32 s12, s12, 1
    s_cmp_eq_u32 s12, 0
    s_cbranch_scc1 L_poll3_done
    s_cbranch_vccnz L_poll3
L_poll3_done:
    v_add_f32 v64, v64, v68
    v_add_f32 v66, v66, v70
    v_add_f32 v64, v64, v72
    v_add_f32 v66, v66, v74
    v_add_f32 v64, v64, v76
    v_add_f32 v66, v66, v78
    v_add_f32 v64, v64, v80
    v_add_f32 v66, v66, v82
    v_add_f32 v64, v64, v84
    v_add_f32 v66, v66, v86
    v_add_f32 v64, v64, v88
    v_add_f32 v66, v66, v90
    v_add_f32 v64, v64, v92
    v_add_f32 v66, v66, v94
    v_add_f32 v64, v64, v96
    v_add_f32 v66, v66, v98
    v_add_f32 v64, v64, v100
    v_add_f32 v66, v66, v102
    v_add_f32 v64, v64, v104
    v_add_f32 v66, v66, v106
    v_add_f32 v64, v64, v108
    v_add_f32 v66, v66, v110
    v_add_f32 v64, v64, v112
    v_add_f32 v66, v66, v114
    v_add_f32 v64, v64, v116
    v_add_f32 v66, v66, v118
    v_add_f32 v64, v64, v120
    v_add_f32 v66, v66, v122
    v_add_f32 v64, v64, v124
    v_add_f32 v66, v66, v126
    v_add_f32 v64, v64, v128
    v_add_f32 v66, v66, v130
    v_add_f32 v64, v64, v132
    v_add_f32 v66, v66, v134
    v_add_f32 v64, v64, v136
    v_add_f32 v66, v66, v138
    v_add_f32 v64, v64, v140
    v_add_f32 v66, v66, v142
    v_add_f32 v64, v64, v144
    v_add_f32 v66, v66, v146
    v_add_f32 v64, v64, v148
    v_add_f32 v66, v66, v150
    v_add_f32 v64, v64, v152
    v_add_f32 v66, v66, v154
    v_add_f32 v64, v64, v156
    v_add_f32 v66, v66, v158
    v_add_f32 v64, v64, v160
    v_add_f32 v66, v66, v162
    v_add_f32 v64, v64, v164
    v_add_f32 v66, v66, v166
    v_add_f32 v64, v64, v168
    v_add_f32 v66, v66, v170
    v_add_f32 v64, v64, v172
    v_add_f32 v66, v66, v174
    v_add_f32 v64, v64, v176
    v_add_f32 v66, v66, v178
    v_add_f32 v64, v64, v180
    v_add_f32 v66, v66, v182
    v_add_f32 v64, v64, v184
    v_add_f32 v66, v66, v186
    v_add_f32 v64, v64, v188
    v_add_f32 v66, v66, v190
    v_add_f32 v64, v64, v192
    v_add_f32 v66, v66, v194
    v_add_f32 v64, v64, v196
    v_add_f32 v66, v66, v198
    v_add_f32 v64, v64, v200
    v_add_f32 v66, v66, v202
    v_add_f32 v64, v64, v204
    v_add_f32 v66, v66, v206
    v_mov_b32 v9, v64
    s_nop 1
    v_permlane32_swap_b32 v64, v9
    s_nop 1
    v_add_f32 v64, v64, v9
    v_mov_b32 v9, v66
    s_nop 1
    v_permlane32_swap_b32 v66, v9
    s_nop 1
    v_add_f32 v66, v66, v9
    v_cvt_pk_bf16_f32 v64, v64, v64
    v_lshlrev_b32 v64, 16, v64
    v_mul_f32 v9, 0xbfb8aa3b, v64
    v_exp_f32 v9, v9
    s_nop 0
    v_add_f32 v9, 1.0, v9
    v_rcp_f32 v9, v9
    s_nop 0
    v_mul_f32 v12, v64, v9
    v_cvt_pk_bf16_f32 v12, v12, v12
    v_lshlrev_b32 v12, 16, v12
    v_cvt_pk_bf16_f32 v66, v66, v66
    v_lshlrev_b32 v66, 16, v66
    v_mul_f32 v9, 0xbfb8aa3b, v66
    v_exp_f32 v9, v9
    s_nop 0
    v_add_f32 v9, 1.0, v9
    v_rcp_f32 v9, v9
    s_nop 0
    v_mul_f32 v13, v66, v9
    v_cvt_pk_bf16_f32 v13, v13, v13
    v_lshlrev_b32 v13, 16, v13
    v_and_b32 v10, 31, v0
    v_lshlrev_b32 v10, 3, v10
    ds_write_b64 v10, v[12:13] offset:1920
    s_waitcnt lgkmcnt(0)
    s_endpgm
L_ffn0:
    s_sub_u32 s78, s5, 8
    s_lshl_b32 s78, s78, 4
    s_add_u32 s78, s78, s4
    s_cmp_ge_u32 s78, 72
    s_cbranch_scc1 L_end
    s_mov_b32 s40, s28
    s_and_b32 s41, s29, 0xffff
    s_mov_b32 s42, 5308416
    s_mov_b32 s43, 0x20000
    s_mov_b32 s44, s30
    s_and_b32 s45, s31, 0xffff
    s_mov_b32 s46, 5308416
    s_mov_b32 s47, 0x20000
    s_mov_b32 s48, s32
    s_and_b32 s49, s33, 0xffff
    s_mov_b32 s50, 5308416
    s_mov_b32 s51, 0x20000
    v_lshlrev_b32 v9, 4, v0
    v_lshlrev_b32 v10, 2, v0
    buffer_load_dwordx4 v[12:15], v9, s[60:63], 0 offen
    buffer_load_dword v16, v10, s[60:63], 0 offen offset:1024
    v_and_b32 v17, 1, v0
    v_lshl_add_u32 v17, v6, 1, v17
    s_mov_b32 s10, 663552
    v_mul_lo_u32 v11, v17, s10
    v_bfe_u32 v17, v0, 1, 3
    v_lshl_add_u32 v11, v17, 4, v11
    s_lshl_b32 s9, s78, 7
    buffer_load_dwordx4 v[104:107], v11, s[40:43], s9 offen nt
    buffer_load_dwordx4 v[108:111], v11, s[44:47], s9 offen nt
    s_add_u32 s9, s9, 9216
    buffer_load_dwordx4 v[112:115], v11, s[40:43], s9 offen nt
    buffer_load_dwordx4 v[116:119], v11, s[44:47], s9 offen nt
    s_add_u32 s9, s9, 9216
    s_waitcnt vmcnt(4)
    v_lshlrev_b32 v18, 16, v12
    v_and_b32 v19, 0xffff0000, v12
    v_lshlrev_b32 v20, 16, v13
    v_and_b32 v21, 0xffff0000, v13
    v_lshlrev_b32 v22, 16, v14
    v_and_b32 v23, 0xffff0000, v14
    v_lshlrev_b32 v24, 16, v15
    v_and_b32 v25, 0xffff0000, v15
    v_lshlrev_b32 v26, 16, v16
    v_and_b32 v27, 0xffff0000, v16
    v_add_f32 v28, v18, v19
    v_add_f32 v28, v28, v20
    v_add_f32 v28, v28, v21
    v_add_f32 v28, v28, v22
    v_add_f32 v28, v28, v23
    v_add_f32 v28, v28, v24
    v_add_f32 v28, v28, v25
    v_add_f32 v28, v28, v26
    v_add_f32 v28, v28, v27
    s_nop 1
    v_add_f32_dpp v28, v28, v28 quad_perm:[1,0,3,2] row_mask:0xf bank_mask:0xf
    s_nop 1
    v_add_f32_dpp v28, v28, v28 quad_perm:[2,3,0,1] row_mask:0xf bank_mask:0xf
    s_nop 1
    v_add_f32_dpp v28, v28, v28 row_half_mirror row_mask:0xf bank_mask:0xf
    s_nop 1
    v_add_f32_dpp v28, v28, v28 row_mirror row_mask:0xf bank_mask:0xf
    v_mov_b32 v29, v28
    s_nop 1
    v_permlane16_swap_b32 v28, v29
    s_nop 1
    v_add_f32 v28, v28, v29
    v_mov_b32 v29, v28
    s_nop 1
    v_permlane32_swap_b32 v28, v29
    s_nop 1
    v_add_f32 v28, v28, v29
    v_mul_f32 v28, 0x3ae38e39, v28
    v_cmp_gt_u32 vcc, 32, v0
    v_sub_f32 v29, v18, v28
    v_mul_f32 v30, v29, v29
    v_sub_f32 v29, v19, v28
    v_fmac_f32 v30, v29, v29
    v_sub_f32 v29, v20, v28
    v_fmac_f32 v30, v29, v29
    v_sub_f32 v29, v21, v28
    v_fmac_f32 v30, v29, v29
    v_sub_f32 v29, v22, v28
    v_fmac_f32 v30, v29, v29
    v_sub_f32 v29, v23, v28
    v_fmac_f32 v30, v29, v29
    v_sub_f32 v29, v24, v28
    v_fmac_f32 v30, v29, v29
    v_sub_f32 v29, v25, v28
    v_fmac_f32 v30, v29, v29
    v_sub_f32 v29, v26, v28
    v_cndmask_b32 v29, 0, v29, vcc
    v_fmac_f32 v30, v29, v29
    v_sub_f32 v29, v27, v28
    v_cndmask_b32 v29, 0, v29, vcc
    v_fmac_f32 v30, v29, v29
    s_nop 1
    v_add_f32_dpp v30, v30, v30 quad_perm:[1,0,3,2] row_mask:0xf bank_mask:0xf
    s_nop 1
    v_add_f32_dpp v30, v30, v30 quad_perm:[2,3,0,1] row_mask:0xf bank_mask:0xf
    s_nop 1
    v_add_f32_dpp v30, v30, v30 row_half_mirror row_mask:0xf bank_mask:0xf
    s_nop 1
    v_add_f32_dpp v30, v30, v30 row_mirror row_mask:0xf bank_mask:0xf
    v_mov_b32 v29, v30
    s_nop 1
    v_permlane16_swap_b32 v30, v29
    s_nop 1
    v_add_f32 v30, v30, v29
    v_mov_b32 v29, v30
    s_nop 1
    v_permlane32_swap_b32 v30, v29
    s_nop 1
    v_add_f32 v30, v30, v29
    v_mul_f32 v30, 0x3ae38e39, v30
    v_cvt_pk_bf16_f32 v30, v30, v30
    v_lshlrev_b32 v30, 16, v30
    v_cvt_pk_bf16_f32 v28, v28, v28
    v_lshlrev_b32 v28, 16, v28
    v_add_f32 v30, 0x3727c5ac, v30
    v_cvt_pk_bf16_f32 v30, v30, v30
    v_lshlrev_b32 v30, 16, v30
    v_sqrt_f32 v30, v30
    s_nop 0
    v_cvt_pk_bf16_f32 v30, v30, v30
    v_lshlrev_b32 v30, 16, v30
    v_rcp_f32 v29, v30
    v_sub_f32 v18, v18, v28
    v_cvt_pk_bf16_f32 v18, v18, v18
    v_lshlrev_b32 v18, 16, v18
    v_sub_f32 v19, v19, v28
    v_cvt_pk_bf16_f32 v19, v19, v19
    v_lshlrev_b32 v19, 16, v19
    v_sub_f32 v20, v20, v28
    v_cvt_pk_bf16_f32 v20, v20, v20
    v_lshlrev_b32 v20, 16, v20
    v_sub_f32 v21, v21, v28
    v_cvt_pk_bf16_f32 v21, v21, v21
    v_lshlrev_b32 v21, 16, v21
    v_sub_f32 v22, v22, v28
    v_cvt_pk_bf16_f32 v22, v22, v22
    v_lshlrev_b32 v22, 16, v22
    v_sub_f32 v23, v23, v28
    v_cvt_pk_bf16_f32 v23, v23, v23
    v_lshlrev_b32 v23, 16, v23
    v_sub_f32 v24, v24, v28
    v_cvt_pk_bf16_f32 v24, v24, v24
    v_lshlrev_b32 v24, 16, v24
    v_sub_f32 v25, v25, v28
    v_cvt_pk_bf16_f32 v25, v25, v25
    v_lshlrev_b32 v25, 16, v25
    v_sub_f32 v26, v26, v28
    v_cvt_pk_bf16_f32 v26, v26, v26
    v_lshlrev_b32 v26, 16, v26
    v_sub_f32 v27, v27, v28
    v_cvt_pk_bf16_f32 v27, v27, v27
    v_lshlrev_b32 v27, 16, v27
    v_mul_f32 v31, v18, v29
    v_fma_f32 v32, -v31, v30, v18
    v_fma_f32 v18, v32, v29, v31
    v_mul_f32 v31, v19, v29
    v_fma_f32 v32, -v31, v30, v19
    v_fma_f32 v19, v32, v29, v31
    v_mul_f32 v31, v20, v29
    v_fma_f32 v32, -v31, v30, v20
    v_fma_f32 v20, v32, v29, v31
    v_mul_f32 v31, v21, v29
    v_fma_f32 v32, -v31, v30, v21
    v_fma_f32 v21, v32, v29, v31
    v_mul_f32 v31, v22, v29
    v_fma_f32 v32, -v31, v30, v22
    v_fma_f32 v22, v32, v29, v31
    v_mul_f32 v31, v23, v29
    v_fma_f32 v32, -v31, v30, v23
    v_fma_f32 v23, v32, v29, v31
    v_mul_f32 v31, v24, v29
    v_fma_f32 v32, -v31, v30, v24
    v_fma_f32 v24, v32, v29, v31
    v_mul_f32 v31, v25, v29
    v_fma_f32 v32, -v31, v30, v25
    v_fma_f32 v25, v32, v29, v31
    v_mul_f32 v31, v26, v29
    v_fma_f32 v32, -v31, v30, v26
    v_fma_f32 v26, v32, v29, v31
    v_mul_f32 v31, v27, v29
    v_fma_f32 v32, -v31, v30, v27
    v_fma_f32 v27, v32, v29, v31
    v_cvt_pk_bf16_f32 v12, v18, v19
    v_cvt_pk_bf16_f32 v13, v20, v21
    v_cvt_pk_bf16_f32 v14, v22, v23
    v_cvt_pk_bf16_f32 v15, v24, v25
    v_cvt_pk_bf16_f32 v16, v26, v27
    ds_write_b128 v9, v[12:15] offset:0
    ds_write_b32 v10, v16 offset:1024
    s_waitcnt lgkmcnt(0)
    v_lshrrev_b32 v10, 3, v0
    v_mul_u32_u24 v10, 144, v10
    ds_read_b128 v[64:67], v10 offset:0
    ds_read_b128 v[68:71], v10 offset:16
    ds_read_b128 v[72:75], v10 offset:32
    ds_read_b128 v[76:79], v10 offset:48
    ds_read_b128 v[80:83], v10 offset:64
    ds_read_b128 v[84:87], v10 offset:80
    ds_read_b128 v[88:91], v10 offset:96
    ds_read_b128 v[92:95], v10 offset:112
    ds_read_b128 v[96:99], v10 offset:128
    s_waitcnt lgkmcnt(0)
    s_mul_i32 s79, s80, 0x9e3779b1
    s_add_u32 s79, s79, 0x7f4a7c15
    s_barrier
    v_perm_b32 v9, v64, v64, s6
    v_and_b32 v56, v2, v9
    v_and_b32 v57, v3, v9
    v_and_b32 v58, v4, v9
    v_and_b32 v59, v5, v9
    s_waitcnt vmcnt(2)
    s_nop 0
    v_mfma_f32_16x16x32_bf16 v[48:51], v[104:107], v[56:59], 0
    v_mfma_f32_16x16x32_bf16 v[52:55], v[108:111], v[56:59], 0
    buffer_load_dwordx4 v[104:107], v11, s[40:43], s9 offen nt
    buffer_load_dwordx4 v[108:111], v11, s[44:47], s9 offen nt
    s_add_u32 s9, s9, 9216
    v_perm_b32 v9, v64, v64, s7
    v_and_b32 v60, v2, v9
    v_and_b32 v61, v3, v9
    v_and_b32 v62, v4, v9
    v_and_b32 v63, v5, v9
    s_waitcnt vmcnt(2)
    s_nop 0
    v_mfma_f32_16x16x32_bf16 v[48:51], v[112:115], v[60:63], v[48:51]
    v_mfma_f32_16x16x32_bf16 v[52:55], v[116:119], v[60:63], v[52:55]
    buffer_load_dwordx4 v[112:115], v11, s[40:43], s9 offen nt
    buffer_load_dwordx4 v[116:119], v11, s[44:47], s9 offen nt
    s_add_u32 s9, s9, 9216
    v_perm_b32 v9, v65, v65, s6
    v_and_b32 v56, v2, v9
    v_and_b32 v57, v3, v9
    v_and_b32 v58, v4, v9
    v_and_b32 v59, v5, v9
    s_waitcnt vmcnt(2)
    s_nop 0
    v_mfma_f32_16x16x32_bf16 v[48:51], v[104:107], v[56:59], v[48:51]
    v_mfma_f32_16x16x32_bf16 v[52:55], v[108:111], v[56:59], v[52:55]
    buffer_load_dwordx4 v[104:107], v11, s[40:43], s9 offen nt
    buffer_load_dwordx4 v[108:111], v11, s[44:47], s9 offen nt
    s_add_u32 s9, s9, 9216
    v_perm_b32 v9, v65, v65, s7
    v_and_b32 v60, v2, v9
    v_and_b32 v61, v3, v9
    v_and_b32 v62, v4, v9
    v_and_b32 v63, v5, v9
    s_waitcnt vmcnt(2)
    s_nop 0
    v_mfma_f32_16x16x32_bf16 v[48:51], v[112:115], v[60:63], v[48:51]
    v_mfma_f32_16x16x32_bf16 v[52:55], v[116:119], v[60:63], v[52:55]
    buffer_load_dwordx4 v[112:115], v11, s[40:43], s9 offen nt
    buffer_load_dwordx4 v[116:119], v11, s[44:47], s9 offen nt
    s_add_u32 s9, s9, 9216
    v_perm_b32 v9, v66, v66, s6
    v_and_b32 v56, v2, v9
    v_and_b32 v57, v3, v9
    v_and_b32 v58, v4, v9
    v_and_b32 v59, v5, v9
    s_waitcnt vmcnt(2)
    s_nop 0
    v_mfma_f32_16x16x32_bf16 v[48:51], v[104:107], v[56:59], v[48:51]
    v_mfma_f32_16x16x32_bf16 v[52:55], v[108:111], v[56:59], v[52:55]
    buffer_load_dwordx4 v[104:107], v11, s[40:43], s9 offen nt
    buffer_load_dwordx4 v[108:111], v11, s[44:47], s9 offen nt
    s_add_u32 s9, s9, 9216
    v_perm_b32 v9, v66, v66, s7
    v_and_b32 v60, v2, v9
    v_and_b32 v61, v3, v9
    v_and_b32 v62, v4, v9
    v_and_b32 v63, v5, v9
    s_waitcnt vmcnt(2)
    s_nop 0
    v_mfma_f32_16x16x32_bf16 v[48:51], v[112:115], v[60:63], v[48:51]
    v_mfma_f32_16x16x32_bf16 v[52:55], v[116:119], v[60:63], v[52:55]
    buffer_load_dwordx4 v[112:115], v11, s[40:43], s9 offen nt
    buffer_load_dwordx4 v[116:119], v11, s[44:47], s9 offen nt
    s_add_u32 s9, s9, 9216
    v_perm_b32 v9, v67, v67, s6
    v_and_b32 v56, v2, v9
    v_and_b32 v57, v3, v9
    v_and_b32 v58, v4, v9
    v_and_b32 v59, v5, v9
    s_waitcnt vmcnt(2)
    s_nop 0
    v_mfma_f32_16x16x32_bf16 v[48:51], v[104:107], v[56:59], v[48:51]
    v_mfma_f32_16x16x32_bf16 v[52:55], v[108:111], v[56:59], v[52:55]
    buffer_load_dwordx4 v[104:107], v11, s[40:43], s9 offen nt
    buffer_load_dwordx4 v[108:111], v11, s[44:47], s9 offen nt
    s_add_u32 s9, s9, 9216
    v_perm_b32 v9, v67, v67, s7
    v_and_b32 v60, v2, v9
    v_and_b32 v61, v3, v9
    v_and_b32 v62, v4, v9
    v_and_b32 v63, v5, v9
    s_waitcnt vmcnt(2)
    s_nop 0
    v_mfma_f32_16x16x32_bf16 v[48:51], v[112:115], v[60:63], v[48:51]
    v_mfma_f32_16x16x32_bf16 v[52:55], v[116:119], v[60:63], v[52:55]
    buffer_load_dwordx4 v[112:115], v11, s[40:43], s9 offen nt
    buffer_load_dwordx4 v[116:119], v11, s[44:47], s9 offen nt
    s_add_u32 s9, s9, 9216
    v_perm_b32 v9, v68, v68, s6
    v_and_b32 v56, v2, v9
    v_and_b32 v57, v3, v9
    v_and_b32 v58, v4, v9
    v_and_b32 v59, v5, v9
    s_waitcnt vmcnt(2)
    s_nop 0
    v_mfma_f32_16x16x32_bf16 v[48:51], v[104:107], v[56:59], v[48:51]
    v_mfma_f32_16x16x32_bf16 v[52:55], v[108:111], v[56:59], v[52:55]
    buffer_load_dwordx4 v[104:107], v11, s[40:43], s9 offen nt
    buffer_load_dwordx4 v[108:111], v11, s[44:47], s9 offen nt
    s_add_u32 s9, s9, 9216
    v_perm_b32 v9, v68, v68, s7
    v_and_b32 v60, v2, v9
    v_and_b32 v61, v3, v9
    v_and_b32 v62, v4, v9
    v_and_b32 v63, v5, v9
    s_waitcnt vmcnt(2)
    s_nop 0
    v_mfma_f32_16x16x32_bf16 v[48:51], v[112:115], v[60:63], v[48:51]
    v_mfma_f32_16x16x32_bf16 v[52:55], v[116:119], v[60:63], v[52:55]
    buffer_load_dwordx4 v[112:115], v11, s[40:43], s9 offen nt
    buffer_load_dwordx4 v[116:119], v11, s[44:47], s9 offen nt
    s_add_u32 s9, s9, 9216
    v_perm_b32 v9, v69, v69, s6
    v_and_b32 v56, v2, v9
    v_and_b32 v57, v3, v9
    v_and_b32 v58, v4, v9
    v_and_b32 v59, v5, v9
    s_waitcnt vmcnt(2)
    s_nop 0
    v_mfma_f32_16x16x32_bf16 v[48:51], v[104:107], v[56:59], v[48:51]
    v_mfma_f32_16x16x32_bf16 v[52:55], v[108:111], v[56:59], v[52:55]
    buffer_load_dwordx4 v[104:107], v11, s[40:43], s9 offen nt
    buffer_load_dwordx4 v[108:111], v11, s[44:47], s9 offen nt
    s_add_u32 s9, s9, 9216
    v_perm_b32 v9, v69, v69, s7
    v_and_b32 v60, v2, v9
    v_and_b32 v61, v3, v9
    v_and_b32 v62, v4, v9
    v_and_b32 v63, v5, v9
    s_waitcnt vmcnt(2)
    s_nop 0
    v_mfma_f32_16x16x32_bf16 v[48:51], v[112:115], v[60:63], v[48:51]
    v_mfma_f32_16x16x32_bf16 v[52:55], v[116:119], v[60:63], v[52:55]
    buffer_load_dwordx4 v[112:115], v11, s[40:43], s9 offen nt
    buffer_load_dwordx4 v[116:119], v11, s[44:47], s9 offen nt
    s_add_u32 s9, s9, 9216
    v_perm_b32 v9, v70, v70, s6
    v_and_b32 v56, v2, v9
    v_and_b32 v57, v3, v9
    v_and_b32 v58, v4, v9
    v_and_b32 v59, v5, v9
    s_waitcnt vmcnt(2)
    s_nop 0
    v_mfma_f32_16x16x32_bf16 v[48:51], v[104:107], v[56:59], v[48:51]
    v_mfma_f32_16x16x32_bf16 v[52:55], v[108:111], v[56:59], v[52:55]
    buffer_load_dwordx4 v[104:107], v11, s[40:43], s9 offen nt
    buffer_load_dwordx4 v[108:111], v11, s[44:47], s9 offen nt
    s_add_u32 s9, s9, 9216
    v_perm_b32 v9, v70, v70, s7
    v_and_b32 v60, v2, v9
    v_and_b32 v61, v3, v9
    v_and_b32 v62, v4, v9
    v_and_b32 v63, v5, v9
    s_waitcnt vmcnt(2)
    s_nop 0
    v_mfma_f32_16x16x32_bf16 v[48:51], v[112:115], v[60:63], v[48:51]
    v_mfma_f32_16x16x32_bf16 v[52:55], v[116:119], v[60:63], v[52:55]
    buffer_load_dwordx4 v[112:115], v11, s[40:43], s9 offen nt
    buffer_load_dwordx4 v[116:119], v11, s[44:47], s9 offen nt
    s_add_u32 s9, s9, 9216
    v_perm_b32 v9, v71, v71, s6
    v_and_b32 v56, v2, v9
    v_and_b32 v57, v3, v9
    v_and_b32 v58, v4, v9
    v_and_b32 v59, v5, v9
    s_waitcnt vmcnt(2)
    s_nop 0
    v_mfma_f32_16x16x32_bf16 v[48:51], v[104:107], v[56:59], v[48:51]
    v_mfma_f32_16x16x32_bf16 v[52:55], v[108:111], v[56:59], v[52:55]
    buffer_load_dwordx4 v[104:107], v11, s[40:43], s9 offen nt
    buffer_load_dwordx4 v[108:111], v11, s[44:47], s9 offen nt
    s_add_u32 s9, s9, 9216
    v_perm_b32 v9, v71, v71, s7
    v_and_b32 v60, v2, v9
    v_and_b32 v61, v3, v9
    v_and_b32 v62, v4, v9
    v_and_b32 v63, v5, v9
    s_waitcnt vmcnt(2)
    s_nop 0
    v_mfma_f32_16x16x32_bf16 v[48:51], v[112:115], v[60:63], v[48:51]
    v_mfma_f32_16x16x32_bf16 v[52:55], v[116:119], v[60:63], v[52:55]
    buffer_load_dwordx4 v[112:115], v11, s[40:43], s9 offen nt
    buffer_load_dwordx4 v[116:119], v11, s[44:47], s9 offen nt
    s_add_u32 s9, s9, 9216
    v_perm_b32 v9, v72, v72, s6
    v_and_b32 v56, v2, v9
    v_and_b32 v57, v3, v9
    v_and_b32 v58, v4, v9
    v_and_b32 v59, v5, v9
    s_waitcnt vmcnt(2)
    s_nop 0
    v_mfma_f32_16x16x32_bf16 v[48:51], v[104:107], v[56:59], v[48:51]
    v_mfma_f32_16x16x32_bf16 v[52:55], v[108:111], v[56:59], v[52:55]
    buffer_load_dwordx4 v[104:107], v11, s[40:43], s9 offen nt
    buffer_load_dwordx4 v[108:111], v11, s[44:47], s9 offen nt
    s_add_u32 s9, s9, 9216
    v_perm_b32 v9, v72, v72, s7
    v_and_b32 v60, v2, v9
    v_and_b32 v61, v3, v9
    v_and_b32 v62, v4, v9
    v_and_b32 v63, v5, v9
    s_waitcnt vmcnt(2)
    s_nop 0
    v_mfma_f32_16x16x32_bf16 v[48:51], v[112:115], v[60:63], v[48:51]
    v_mfma_f32_16x16x32_bf16 v[52:55], v[116:119], v[60:63], v[52:55]
    buffer_load_dwordx4 v[112:115], v11, s[40:43], s9 offen nt
    buffer_load_dwordx4 v[116:119], v11, s[44:47], s9 offen nt
    s_add_u32 s9, s9, 9216
    v_perm_b32 v9, v73, v73, s6
    v_and_b32 v56, v2, v9
    v_and_b32 v57, v3, v9
    v_and_b32 v58, v4, v9
    v_and_b32 v59, v5, v9
    s_waitcnt vmcnt(2)
    s_nop 0
    v_mfma_f32_16x16x32_bf16 v[48:51], v[104:107], v[56:59], v[48:51]
    v_mfma_f32_16x16x32_bf16 v[52:55], v[108:111], v[56:59], v[52:55]
    buffer_load_dwordx4 v[104:107], v11, s[40:43], s9 offen nt
    buffer_load_dwordx4 v[108:111], v11, s[44:47], s9 offen nt
    s_add_u32 s9, s9, 9216
    v_perm_b32 v9, v73, v73, s7
    v_and_b32 v60, v2, v9
    v_and_b32 v61, v3, v9
    v_and_b32 v62, v4, v9
    v_and_b32 v63, v5, v9
    s_waitcnt vmcnt(2)
    s_nop 0
    v_mfma_f32_16x16x32_bf16 v[48:51], v[112:115], v[60:63], v[48:51]
    v_mfma_f32_16x16x32_bf16 v[52:55], v[116:119], v[60:63], v[52:55]
    buffer_load_dwordx4 v[112:115], v11, s[40:43], s9 offen nt
    buffer_load_dwordx4 v[116:119], v11, s[44:47], s9 offen nt
    s_add_u32 s9, s9, 9216
    v_perm_b32 v9, v74, v74, s6
    v_and_b32 v56, v2, v9
    v_and_b32 v57, v3, v9
    v_and_b32 v58, v4, v9
    v_and_b32 v59, v5, v9
    s_waitcnt vmcnt(2)
    s_nop 0
    v_mfma_f32_16x16x32_bf16 v[48:51], v[104:107], v[56:59], v[48:51]
    v_mfma_f32_16x16x32_bf16 v[52:55], v[108:111], v[56:59], v[52:55]
    buffer_load_dwordx4 v[104:107], v11, s[40:43], s9 offen nt
    buffer_load_dwordx4 v[108:111], v11, s[44:47], s9 offen nt
    s_add_u32 s9, s9, 9216
    v_perm_b32 v9, v74, v74, s7
    v_and_b32 v60, v2, v9
    v_and_b32 v61, v3, v9
    v_and_b32 v62, v4, v9
    v_and_b32 v63, v5, v9
    s_waitcnt vmcnt(2)
    s_nop 0
    v_mfma_f32_16x16x32_bf16 v[48:51], v[112:115], v[60:63], v[48:51]
    v_mfma_f32_16x16x32_bf16 v[52:55], v[116:119], v[60:63], v[52:55]
    buffer_load_dwordx4 v[112:115], v11, s[40:43], s9 offen nt
    buffer_load_dwordx4 v[116:119], v11, s[44:47], s9 offen nt
    s_add_u32 s9, s9, 9216
    v_perm_b32 v9, v75, v75, s6
    v_and_b32 v56, v2, v9
    v_and_b32 v57, v3, v9
    v_and_b32 v58, v4, v9
    v_and_b32 v59, v5, v9
    s_waitcnt vmcnt(2)
    s_nop 0
    v_mfma_f32_16x16x32_bf16 v[48:51], v[104:107], v[56:59], v[48:51]
    v_mfma_f32_16x16x32_bf16 v[52:55], v[108:111], v[56:59], v[52:55]
    buffer_load_dwordx4 v[104:107], v11, s[40:43], s9 offen nt
    buffer_load_dwordx4 v[108:111], v11, s[44:47], s9 offen nt
    s_add_u32 s9, s9, 9216
    v_perm_b32 v9, v75, v75, s7
    v_and_b32 v60, v2, v9
    v_and_b32 v61, v3, v9
    v_and_b32 v62, v4, v9
    v_and_b32 v63, v5, v9
    s_waitcnt vmcnt(2)
    s_nop 0
    v_mfma_f32_16x16x32_bf16 v[48:51], v[112:115], v[60:63], v[48:51]
    v_mfma_f32_16x16x32_bf16 v[52:55], v[116:119], v[60:63], v[52:55]
    buffer_load_dwordx4 v[112:115], v11, s[40:43], s9 offen nt
    buffer_load_dwordx4 v[116:119], v11, s[44:47], s9 offen nt
    s_add_u32 s9, s9, 9216
    v_perm_b32 v9, v76, v76, s6
    v_and_b32 v56, v2, v9
    v_and_b32 v57, v3, v9
    v_and_b32 v58, v4, v9
    v_and_b32 v59, v5, v9
    s_waitcnt vmcnt(2)
    s_nop 0
    v_mfma_f32_16x16x32_bf16 v[48:51], v[104:107], v[56:59], v[48:51]
    v_mfma_f32_16x16x32_bf16 v[52:55], v[108:111], v[56:59], v[52:55]
    buffer_load_dwordx4 v[104:107], v11, s[40:43], s9 offen nt
    buffer_load_dwordx4 v[108:111], v11, s[44:47], s9 offen nt
    s_add_u32 s9, s9, 9216
    v_perm_b32 v9, v76, v76, s7
    v_and_b32 v60, v2, v9
    v_and_b32 v61, v3, v9
    v_and_b32 v62, v4, v9
    v_and_b32 v63, v5, v9
    s_waitcnt vmcnt(2)
    s_nop 0
    v_mfma_f32_16x16x32_bf16 v[48:51], v[112:115], v[60:63], v[48:51]
    v_mfma_f32_16x16x32_bf16 v[52:55], v[116:119], v[60:63], v[52:55]
    buffer_load_dwordx4 v[112:115], v11, s[40:43], s9 offen nt
    buffer_load_dwordx4 v[116:119], v11, s[44:47], s9 offen nt
    s_add_u32 s9, s9, 9216
    v_perm_b32 v9, v77, v77, s6
    v_and_b32 v56, v2, v9
    v_and_b32 v57, v3, v9
    v_and_b32 v58, v4, v9
    v_and_b32 v59, v5, v9
    s_waitcnt vmcnt(2)
    s_nop 0
    v_mfma_f32_16x16x32_bf16 v[48:51], v[104:107], v[56:59], v[48:51]
    v_mfma_f32_16x16x32_bf16 v[52:55], v[108:111], v[56:59], v[52:55]
    buffer_load_dwordx4 v[104:107], v11, s[40:43], s9 offen nt
    buffer_load_dwordx4 v[108:111], v11, s[44:47], s9 offen nt
    s_add_u32 s9, s9, 9216
    v_perm_b32 v9, v77, v77, s7
    v_and_b32 v60, v2, v9
    v_and_b32 v61, v3, v9
    v_and_b32 v62, v4, v9
    v_and_b32 v63, v5, v9
    s_waitcnt vmcnt(2)
    s_nop 0
    v_mfma_f32_16x16x32_bf16 v[48:51], v[112:115], v[60:63], v[48:51]
    v_mfma_f32_16x16x32_bf16 v[52:55], v[116:119], v[60:63], v[52:55]
    buffer_load_dwordx4 v[112:115], v11, s[40:43], s9 offen nt
    buffer_load_dwordx4 v[116:119], v11, s[44:47], s9 offen nt
    s_add_u32 s9, s9, 9216
    v_perm_b32 v9, v78, v78, s6
    v_and_b32 v56, v2, v9
    v_and_b32 v57, v3, v9
    v_and_b32 v58, v4, v9
    v_and_b32 v59, v5, v9
    s_waitcnt vmcnt(2)
    s_nop 0
    v_mfma_f32_16x16x32_bf16 v[48:51], v[104:107], v[56:59], v[48:51]
    v_mfma_f32_16x16x32_bf16 v[52:55], v[108:111], v[56:59], v[52:55]
    buffer_load_dwordx4 v[104:107], v11, s[40:43], s9 offen nt
    buffer_load_dwordx4 v[108:111], v11, s[44:47], s9 offen nt
    s_add_u32 s9, s9, 9216
    v_perm_b32 v9, v78, v78, s7
    v_and_b32 v60, v2, v9
    v_and_b32 v61, v3, v9
    v_and_b32 v62, v4, v9
    v_and_b32 v63, v5, v9
    s_waitcnt vmcnt(2)
    s_nop 0
    v_mfma_f32_16x16x32_bf16 v[48:51], v[112:115], v[60:63], v[48:51]
    v_mfma_f32_16x16x32_bf16 v[52:55], v[116:119], v[60:63], v[52:55]
    buffer_load_dwordx4 v[112:115], v11, s[40:43], s9 offen nt
    buffer_load_dwordx4 v[116:119], v11, s[44:47], s9 offen nt
    s_add_u32 s9, s9, 9216
    v_perm_b32 v9, v79, v79, s6
    v_and_b32 v56, v2, v9
    v_and_b32 v57, v3, v9
    v_and_b32 v58, v4, v9
    v_and_b32 v59, v5, v9
    s_waitcnt vmcnt(2)
    s_nop 0
    v_mfma_f32_16x16x32_bf16 v[48:51], v[104:107], v[56:59], v[48:51]
    v_mfma_f32_16x16x32_bf16 v[52:55], v[108:111], v[56:59], v[52:55]
    buffer_load_dwordx4 v[104:107], v11, s[40:43], s9 offen nt
    buffer_load_dwordx4 v[108:111], v11, s[44:47], s9 offen nt
    s_add_u32 s9, s9, 9216
    v_perm_b32 v9, v79, v79, s7
    v_and_b32 v60, v2, v9
    v_and_b32 v61, v3, v9
    v_and_b32 v62, v4, v9
    v_and_b32 v63, v5, v9
    s_waitcnt vmcnt(2)
    s_nop 0
    v_mfma_f32_16x16x32_bf16 v[48:51], v[112:115], v[60:63], v[48:51]
    v_mfma_f32_16x16x32_bf16 v[52:55], v[116:119], v[60:63], v[52:55]
    buffer_load_dwordx4 v[112:115], v11, s[40:43], s9 offen nt
    buffer_load_dwordx4 v[116:119], v11, s[44:47], s9 offen nt
    s_add_u32 s9, s9, 9216
    v_perm_b32 v9, v80, v80, s6
    v_and_b32 v56, v2, v9
    v_and_b32 v57, v3, v9
    v_and_b32 v58, v4, v9
    v_and_b32 v59, v5, v9
    s_waitcnt vmcnt(2)
    s_nop 0
    v_mfma_f32_16x16x32_bf16 v[48:51], v[104:107], v[56:59], v[48:51]
    v_mfma_f32_16x16x32_bf16 v[52:55], v[108:111], v[56:59], v[52:55]
    buffer_load_dwordx4 v[104:107], v11, s[40:43], s9 offen nt
    buffer_load_dwordx4 v[108:111], v11, s[44:47], s9 offen nt
    s_add_u32 s9, s9, 9216
    v_perm_b32 v9, v80, v80, s7
    v_and_b32 v60, v2, v9
    v_and_b32 v61, v3, v9
    v_and_b32 v62, v4, v9
    v_and_b32 v63, v5, v9
    s_waitcnt vmcnt(2)
    s_nop 0
    v_mfma_f32_16x16x32_bf16 v[48:51], v[112:115], v[60:63], v[48:51]
    v_mfma_f32_16x16x32_bf16 v[52:55], v[116:119], v[60:63], v[52:55]
    buffer_load_dwordx4 v[112:115], v11, s[40:43], s9 offen nt
    buffer_load_dwordx4 v[116:119], v11, s[44:47], s9 offen nt
    s_add_u32 s9, s9, 9216
    v_perm_b32 v9, v81, v81, s6
    v_and_b32 v56, v2, v9
    v_and_b32 v57, v3, v9
    v_and_b32 v58, v4, v9
    v_and_b32 v59, v5, v9
    s_waitcnt vmcnt(2)
    s_nop 0
    v_mfma_f32_16x16x32_bf16 v[48:51], v[104:107], v[56:59], v[48:51]
    v_mfma_f32_16x16x32_bf16 v[52:55], v[108:111], v[56:59], v[52:55]
    buffer_load_dwordx4 v[104:107], v11, s[40:43], s9 offen nt
    buffer_load_dwordx4 v[108:111], v11, s[44:47], s9 offen nt
    s_add_u32 s9, s9, 9216
    v_perm_b32 v9, v81, v81, s7
    v_and_b32 v60, v2, v9
    v_and_b32 v61, v3, v9
    v_and_b32 v62, v4, v9
    v_and_b32 v63, v5, v9
    s_waitcnt vmcnt(2)
    s_nop 0
    v_mfma_f32_16x16x32_bf16 v[48:51], v[112:115], v[60:63], v[48:51]
    v_mfma_f32_16x16x32_bf16 v[52:55], v[116:119], v[60:63], v[52:55]
    buffer_load_dwordx4 v[112:115], v11, s[40:43], s9 offen nt
    buffer_load_dwordx4 v[116:119], v11, s[44:47], s9 offen nt
    s_add_u32 s9, s9, 9216
    v_perm_b32 v9, v82, v82, s6
    v_and_b32 v56, v2, v9
    v_and_b32 v57, v3, v9
    v_and_b32 v58, v4, v9
    v_and_b32 v59, v5, v9
    s_waitcnt vmcnt(2)
    s_nop 0
    v_mfma_f32_16x16x32_bf16 v[48:51], v[104:107], v[56:59], v[48:51]
    v_mfma_f32_16x16x32_bf16 v[52:55], v[108:111], v[56:59], v[52:55]
    buffer_load_dwordx4 v[104:107], v11, s[40:43], s9 offen nt
    buffer_load_dwordx4 v[108:111], v11, s[44:47], s9 offen nt
    s_add_u32 s9, s9, 9216
    v_perm_b32 v9, v82, v82, s7
    v_and_b32 v60, v2, v9
    v_and_b32 v61, v3, v9
    v_and_b32 v62, v4, v9
    v_and_b32 v63, v5, v9
    s_waitcnt vmcnt(2)
    s_nop 0
    v_mfma_f32_16x16x32_bf16 v[48:51], v[112:115], v[60:63], v[48:51]
    v_mfma_f32_16x16x32_bf16 v[52:55], v[116:119], v[60:63], v[52:55]
    buffer_load_dwordx4 v[112:115], v11, s[40:43], s9 offen nt
    buffer_load_dwordx4 v[116:119], v11, s[44:47], s9 offen nt
    s_add_u32 s9, s9, 9216
    v_perm_b32 v9, v83, v83, s6
    v_and_b32 v56, v2, v9
    v_and_b32 v57, v3, v9
    v_and_b32 v58, v4, v9
    v_and_b32 v59, v5, v9
    s_waitcnt vmcnt(2)
    s_nop 0
    v_mfma_f32_16x16x32_bf16 v[48:51], v[104:107], v[56:59], v[48:51]
    v_mfma_f32_16x16x32_bf16 v[52:55], v[108:111], v[56:59], v[52:55]
    buffer_load_dwordx4 v[104:107], v11, s[40:43], s9 offen nt
    buffer_load_dwordx4 v[108:111], v11, s[44:47], s9 offen nt
    s_add_u32 s9, s9, 9216
    v_perm_b32 v9, v83, v83, s7
    v_and_b32 v60, v2, v9
    v_and_b32 v61, v3, v9
    v_and_b32 v62, v4, v9
    v_and_b32 v63, v5, v9
    s_waitcnt vmcnt(2)
    s_nop 0
    v_mfma_f32_16x16x32_bf16 v[48:51], v[112:115], v[60:63], v[48:51]
    v_mfma_f32_16x16x32_bf16 v[52:55], v[116:119], v[60:63], v[52:55]
    buffer_load_dwordx4 v[112:115], v11, s[40:43], s9 offen nt
    buffer_load_dwordx4 v[116:119], v11, s[44:47], s9 offen nt
    s_add_u32 s9, s9, 9216
    v_perm_b32 v9, v84, v84, s6
    v_and_b32 v56, v2, v9
    v_and_b32 v57, v3, v9
    v_and_b32 v58, v4, v9
    v_and_b32 v59, v5, v9
    s_waitcnt vmcnt(2)
    s_nop 0
    v_mfma_f32_16x16x32_bf16 v[48:51], v[104:107], v[56:59], v[48:51]
    v_mfma_f32_16x16x32_bf16 v[52:55], v[108:111], v[56:59], v[52:55]
    buffer_load_dwordx4 v[104:107], v11, s[40:43], s9 offen nt
    buffer_load_dwordx4 v[108:111], v11, s[44:47], s9 offen nt
    s_add_u32 s9, s9, 9216
    v_perm_b32 v9, v84, v84, s7
    v_and_b32 v60, v2, v9
    v_and_b32 v61, v3, v9
    v_and_b32 v62, v4, v9
    v_and_b32 v63, v5, v9
    s_waitcnt vmcnt(2)
    s_nop 0
    v_mfma_f32_16x16x32_bf16 v[48:51], v[112:115], v[60:63], v[48:51]
    v_mfma_f32_16x16x32_bf16 v[52:55], v[116:119], v[60:63], v[52:55]
    buffer_load_dwordx4 v[112:115], v11, s[40:43], s9 offen nt
    buffer_load_dwordx4 v[116:119], v11, s[44:47], s9 offen nt
    s_add_u32 s9, s9, 9216
    v_perm_b32 v9, v85, v85, s6
    v_and_b32 v56, v2, v9
    v_and_b32 v57, v3, v9
    v_and_b32 v58, v4, v9
    v_and_b32 v59, v5, v9
    s_waitcnt vmcnt(2)
    s_nop 0
    v_mfma_f32_16x16x32_bf16 v[48:51], v[104:107], v[56:59], v[48:51]
    v_mfma_f32_16x16x32_bf16 v[52:55], v[108:111], v[56:59], v[52:55]
    buffer_load_dwordx4 v[104:107], v11, s[40:43], s9 offen nt
    buffer_load_dwordx4 v[108:111], v11, s[44:47], s9 offen nt
    s_add_u32 s9, s9, 9216
    v_perm_b32 v9, v85, v85, s7
    v_and_b32 v60, v2, v9
    v_and_b32 v61, v3, v9
    v_and_b32 v62, v4, v9
    v_and_b32 v63, v5, v9
    s_waitcnt vmcnt(2)
    s_nop 0
    v_mfma_f32_16x16x32_bf16 v[48:51], v[112:115], v[60:63], v[48:51]
    v_mfma_f32_16x16x32_bf16 v[52:55], v[116:119], v[60:63], v[52:55]
    buffer_load_dwordx4 v[112:115], v11, s[40:43], s9 offen nt
    buffer_load_dwordx4 v[116:119], v11, s[44:47], s9 offen nt
    s_add_u32 s9, s9, 9216
    v_perm_b32 v9, v86, v86, s6
    v_and_b32 v56, v2, v9
    v_and_b32 v57, v3, v9
    v_and_b32 v58, v4, v9
    v_and_b32 v59, v5, v9
    s_waitcnt vmcnt(2)
    s_nop 0
    v_mfma_f32_16x16x32_bf16 v[48:51], v[104:107], v[56:59], v[48:51]
    v_mfma_f32_16x16x32_bf16 v[52:55], v[108:111], v[56:59], v[52:55]
    buffer_load_dwordx4 v[104:107], v11, s[40:43], s9 offen nt
    buffer_load_dwordx4 v[108:111], v11, s[44:47], s9 offen nt
    s_add_u32 s9, s9, 9216
    v_perm_b32 v9, v86, v86, s7
    v_and_b32 v60, v2, v9
    v_and_b32 v61, v3, v9
    v_and_b32 v62, v4, v9
    v_and_b32 v63, v5, v9
    s_waitcnt vmcnt(2)
    s_nop 0
    v_mfma_f32_16x16x32_bf16 v[48:51], v[112:115], v[60:63], v[48:51]
    v_mfma_f32_16x16x32_bf16 v[52:55], v[116:119], v[60:63], v[52:55]
    buffer_load_dwordx4 v[112:115], v11, s[40:43], s9 offen nt
    buffer_load_dwordx4 v[116:119], v11, s[44:47], s9 offen nt
    s_add_u32 s9, s9, 9216
    v_perm_b32 v9, v87, v87, s6
    v_and_b32 v56, v2, v9
    v_and_b32 v57, v3, v9
    v_and_b32 v58, v4, v9
    v_and_b32 v59, v5, v9
    s_waitcnt vmcnt(2)
    s_nop 0
    v_mfma_f32_16x16x32_bf16 v[48:51], v[104:107], v[56:59], v[48:51]
    v_mfma_f32_16x16x32_bf16 v[52:55], v[108:111], v[56:59], v[52:55]
    buffer_load_dwordx4 v[104:107], v11, s[40:43], s9 offen nt
    buffer_load_dwordx4 v[108:111], v11, s[44:47], s9 offen nt
    s_add_u32 s9, s9, 9216
    v_perm_b32 v9, v87, v87, s7
    v_and_b32 v60, v2, v9
    v_and_b32 v61, v3, v9
    v_and_b32 v62, v4, v9
    v_and_b32 v63, v5, v9
    s_waitcnt vmcnt(2)
    s_nop 0
    v_mfma_f32_16x16x32_bf16 v[48:51], v[112:115], v[60:63], v[48:51]
    v_mfma_f32_16x16x32_bf16 v[52:55], v[116:119], v[60:63], v[52:55]
    buffer_load_dwordx4 v[112:115], v11, s[40:43], s9 offen nt
    buffer_load_dwordx4 v[116:119], v11, s[44:47], s9 offen nt
    s_add_u32 s9, s9, 9216
    v_perm_b32 v9, v88, v88, s6
    v_and_b32 v56, v2, v9
    v_and_b32 v57, v3, v9
    v_and_b32 v58, v4, v9
    v_and_b32 v59, v5, v9
    s_waitcnt vmcnt(2)
    s_nop 0
    v_mfma_f32_16x16x32_bf16 v[48:51], v[104:107], v[56:59], v[48:51]
    v_mfma_f32_16x16x32_bf16 v[52:55], v[108:111], v[56:59], v[52:55]
    buffer_load_dwordx4 v[104:107], v11, s[40:43], s9 offen nt
    buffer_load_dwordx4 v[108:111], v11, s[44:47], s9 offen nt
    s_add_u32 s9, s9, 9216
    v_perm_b32 v9, v88, v88, s7
    v_and_b32 v60, v2, v9
    v_and_b32 v61, v3, v9
    v_and_b32 v62, v4, v9
    v_and_b32 v63, v5, v9
    s_waitcnt vmcnt(2)
    s_nop 0
    v_mfma_f32_16x16x32_bf16 v[48:51], v[112:115], v[60:63], v[48:51]
    v_mfma_f32_16x16x32_bf16 v[52:55], v[116:119], v[60:63], v[52:55]
    buffer_load_dwordx4 v[112:115], v11, s[40:43], s9 offen nt
    buffer_load_dwordx4 v[116:119], v11, s[44:47], s9 offen nt
    s_add_u32 s9, s9, 9216
    v_perm_b32 v9, v89, v89, s6
    v_and_b32 v56, v2, v9
    v_and_b32 v57, v3, v9
    v_and_b32 v58, v4, v9
    v_and_b32 v59, v5, v9
    s_waitcnt vmcnt(2)
    s_nop 0
    v_mfma_f32_16x16x32_bf16 v[48:51], v[104:107], v[56:59], v[48:51]
    v_mfma_f32_16x16x32_bf16 v[52:55], v[108:111], v[56:59], v[52:55]
    buffer_load_dwordx4 v[104:107], v11, s[40:43], s9 offen nt
    buffer_load_dwordx4 v[108:111], v11, s[44:47], s9 offen nt
    s_add_u32 s9, s9, 9216
    v_perm_b32 v9, v89, v89, s7
    v_and_b32 v60, v2, v9
    v_and_b32 v61, v3, v9
    v_and_b32 v62, v4, v9
    v_and_b32 v63, v5, v9
    s_waitcnt vmcnt(2)
    s_nop 0
    v_mfma_f32_16x16x32_bf16 v[48:51], v[112:115], v[60:63], v[48:51]
    v_mfma_f32_16x16x32_bf16 v[52:55], v[116:119], v[60:63], v[52:55]
    buffer_load_dwordx4 v[112:115], v11, s[40:43], s9 offen nt
    buffer_load_dwordx4 v[116:119], v11, s[44:47], s9 offen nt
    s_add_u32 s9, s9, 9216
    v_perm_b32 v9, v90, v90, s6
    v_and_b32 v56, v2, v9
    v_and_b32 v57, v3, v9
    v_and_b32 v58, v4, v9
    v_and_b32 v59, v5, v9
    s_waitcnt vmcnt(2)
    s_nop 0
    v_mfma_f32_16x16x32_bf16 v[48:51], v[104:107], v[56:59], v[48:51]
    v_mfma_f32_16x16x32_bf16 v[52:55], v[108:111], v[56:59], v[52:55]
    buffer_load_dwordx4 v[104:107], v11, s[40:43], s9 offen nt
    buffer_load_dwordx4 v[108:111], v11, s[44:47], s9 offen nt
    s_add_u32 s9, s9, 9216
    v_perm_b32 v9, v90, v90, s7
    v_and_b32 v60, v2, v9
    v_and_b32 v61, v3, v9
    v_and_b32 v62, v4, v9
    v_and_b32 v63, v5, v9
    s_waitcnt vmcnt(2)
    s_nop 0
    v_mfma_f32_16x16x32_bf16 v[48:51], v[112:115], v[60:63], v[48:51]
    v_mfma_f32_16x16x32_bf16 v[52:55], v[116:119], v[60:63], v[52:55]
    buffer_load_dwordx4 v[112:115], v11, s[40:43], s9 offen nt
    buffer_load_dwordx4 v[116:119], v11, s[44:47], s9 offen nt
    s_add_u32 s9, s9, 9216
    v_perm_b32 v9, v91, v91, s6
    v_and_b32 v56, v2, v9
    v_and_b32 v57, v3, v9
    v_and_b32 v58, v4, v9
    v_and_b32 v59, v5, v9
    s_waitcnt vmcnt(2)
    s_nop 0
    v_mfma_f32_16x16x32_bf16 v[48:51], v[104:107], v[56:59], v[48:51]
    v_mfma_f32_16x16x32_bf16 v[52:55], v[108:111], v[56:59], v[52:55]
    buffer_load_dwordx4 v[104:107], v11, s[40:43], s9 offen nt
    buffer_load_dwordx4 v[108:111], v11, s[44:47], s9 offen nt
    s_add_u32 s9, s9, 9216
    v_perm_b32 v9, v91, v91, s7
    v_and_b32 v60, v2, v9
    v_and_b32 v61, v3, v9
    v_and_b32 v62, v4, v9
    v_and_b32 v63, v5, v9
    s_waitcnt vmcnt(2)
    s_nop 0
    v_mfma_f32_16x16x32_bf16 v[48:51], v[112:115], v[60:63], v[48:51]
    v_mfma_f32_16x16x32_bf16 v[52:55], v[116:119], v[60:63], v[52:55]
    buffer_load_dwordx4 v[112:115], v11, s[40:43], s9 offen nt
    buffer_load_dwordx4 v[116:119], v11, s[44:47], s9 offen nt
    s_add_u32 s9, s9, 9216
    v_perm_b32 v9, v92, v92, s6
    v_and_b32 v56, v2, v9
    v_and_b32 v57, v3, v9
    v_and_b32 v58, v4, v9
    v_and_b32 v59, v5, v9
    s_waitcnt vmcnt(2)
    s_nop 0
    v_mfma_f32_16x16x32_bf16 v[48:51], v[104:107], v[56:59], v[48:51]
    v_mfma_f32_16x16x32_bf16 v[52:55], v[108:111], v[56:59], v[52:55]
    buffer_load_dwordx4 v[104:107], v11, s[40:43], s9 offen nt
    buffer_load_dwordx4 v[108:111], v11, s[44:47], s9 offen nt
    s_add_u32 s9, s9, 9216
    v_perm_b32 v9, v92, v92, s7
    v_and_b32 v60, v2, v9
    v_and_b32 v61, v3, v9
    v_and_b32 v62, v4, v9
    v_and_b32 v63, v5, v9
    s_waitcnt vmcnt(2)
    s_nop 0
    v_mfma_f32_16x16x32_bf16 v[48:51], v[112:115], v[60:63], v[48:51]
    v_mfma_f32_16x16x32_bf16 v[52:55], v[116:119], v[60:63], v[52:55]
    buffer_load_dwordx4 v[112:115], v11, s[40:43], s9 offen nt
    buffer_load_dwordx4 v[116:119], v11, s[44:47], s9 offen nt
    s_add_u32 s9, s9, 9216
    v_perm_b32 v9, v93, v93, s6
    v_and_b32 v56, v2, v9
    v_and_b32 v57, v3, v9
    v_and_b32 v58, v4, v9
    v_and_b32 v59, v5, v9
    s_waitcnt vmcnt(2)
    s_nop 0
    v_mfma_f32_16x16x32_bf16 v[48:51], v[104:107], v[56:59], v[48:51]
    v_mfma_f32_16x16x32_bf16 v[52:55], v[108:111], v[56:59], v[52:55]
    buffer_load_dwordx4 v[104:107], v11, s[40:43], s9 offen nt
    buffer_load_dwordx4 v[108:111], v11, s[44:47], s9 offen nt
    s_add_u32 s9, s9, 9216
    v_perm_b32 v9, v93, v93, s7
    v_and_b32 v60, v2, v9
    v_and_b32 v61, v3, v9
    v_and_b32 v62, v4, v9
    v_and_b32 v63, v5, v9
    s_waitcnt vmcnt(2)
    s_nop 0
    v_mfma_f32_16x16x32_bf16 v[48:51], v[112:115], v[60:63], v[48:51]
    v_mfma_f32_16x16x32_bf16 v[52:55], v[116:119], v[60:63], v[52:55]
    buffer_load_dwordx4 v[112:115], v11, s[40:43], s9 offen nt
    buffer_load_dwordx4 v[116:119], v11, s[44:47], s9 offen nt
    s_add_u32 s9, s9, 9216
    v_perm_b32 v9, v94, v94, s6
    v_and_b32 v56, v2, v9
    v_and_b32 v57, v3, v9
    v_and_b32 v58, v4, v9
    v_and_b32 v59, v5, v9
    s_waitcnt vmcnt(2)
    s_nop 0
    v_mfma_f32_16x16x32_bf16 v[48:51], v[104:107], v[56:59], v[48:51]
    v_mfma_f32_16x16x32_bf16 v[52:55], v[108:111], v[56:59], v[52:55]
    buffer_load_dwordx4 v[104:107], v11, s[40:43], s9 offen nt
    buffer_load_dwordx4 v[108:111], v11, s[44:47], s9 offen nt
    s_add_u32 s9, s9, 9216
    v_perm_b32 v9, v94, v94, s7
    v_and_b32 v60, v2, v9
    v_and_b32 v61, v3, v9
    v_and_b32 v62, v4, v9
    v_and_b32 v63, v5, v9
    s_waitcnt vmcnt(2)
    s_nop 0
    v_mfma_f32_16x16x32_bf16 v[48:51], v[112:115], v[60:63], v[48:51]
    v_mfma_f32_16x16x32_bf16 v[52:55], v[116:119], v[60:63], v[52:55]
    buffer_load_dwordx4 v[112:115], v11, s[40:43], s9 offen nt
    buffer_load_dwordx4 v[116:119], v11, s[44:47], s9 offen nt
    s_add_u32 s9, s9, 9216
    v_perm_b32 v9, v95, v95, s6
    v_and_b32 v56, v2, v9
    v_and_b32 v57, v3, v9
    v_and_b32 v58, v4, v9
    v_and_b32 v59, v5, v9
    s_waitcnt vmcnt(2)
    s_nop 0
    v_mfma_f32_16x16x32_bf16 v[48:51], v[104:107], v[56:59], v[48:51]
    v_mfma_f32_16x16x32_bf16 v[52:55], v[108:111], v[56:59], v[52:55]
    buffer_load_dwordx4 v[104:107], v11, s[40:43], s9 offen nt
    buffer_load_dwordx4 v[108:111], v11, s[44:47], s9 offen nt
    s_add_u32 s9, s9, 9216
    v_perm_b32 v9, v95, v95, s7
    v_and_b32 v60, v2, v9
    v_and_b32 v61, v3, v9
    v_and_b32 v62, v4, v9
    v_and_b32 v63, v5, v9
    s_waitcnt vmcnt(2)
    s_nop 0
    v_mfma_f32_16x16x32_bf16 v[48:51], v[112:115], v[60:63], v[48:51]
    v_mfma_f32_16x16x32_bf16 v[52:55], v[116:119], v[60:63], v[52:55]
    buffer_load_dwordx4 v[112:115], v11, s[40:43], s9 offen nt
    buffer_load_dwordx4 v[116:119], v11, s[44:47], s9 offen nt
    s_add_u32 s9, s9, 9216
    v_perm_b32 v9, v96, v96, s6
    v_and_b32 v56, v2, v9
    v_and_b32 v57, v3, v9
    v_and_b32 v58, v4, v9
    v_and_b32 v59, v5, v9
    s_waitcnt vmcnt(2)
    s_nop 0
    v_mfma_f32_16x16x32_bf16 v[48:51], v[104:107], v[56:59], v[48:51]
    v_mfma_f32_16x16x32_bf16 v[52:55], v[108:111], v[56:59], v[52:55]
    buffer_load_dwordx4 v[104:107], v11, s[40:43], s9 offen nt
    buffer_load_dwordx4 v[108:111], v11, s[44:47], s9 offen nt
    s_add_u32 s9, s9, 9216
    v_perm_b32 v9, v96, v96, s7
    v_and_b32 v60, v2, v9
    v_and_b32 v61, v3, v9
    v_and_b32 v62, v4, v9
    v_and_b32 v63, v5, v9
    s_waitcnt vmcnt(2)
    s_nop 0
    v_mfma_f32_16x16x32_bf16 v[48:51], v[112:115], v[60:63], v[48:51]
    v_mfma_f32_16x16x32_bf16 v[52:55], v[116:119], v[60:63], v[52:55]
    buffer_load_dwordx4 v[112:115], v11, s[40:43], s9 offen nt
    buffer_load_dwordx4 v[116:119], v11, s[44:47], s9 offen nt
    s_add_u32 s9, s9, 9216
    v_perm_b32 v9, v97, v97, s6
    v_and_b32 v56, v2, v9
    v_and_b32 v57, v3, v9
    v_and_b32 v58, v4, v9
    v_and_b32 v59, v5, v9
    s_waitcnt vmcnt(2)
    s_nop 0
    v_mfma_f32_16x16x32_bf16 v[48:51], v[104:107], v[56:59], v[48:51]
    v_mfma_f32_16x16x32_bf16 v[52:55], v[108:111], v[56:59], v[52:55]
    buffer_load_dwordx4 v[104:107], v11, s[40:43], s9 offen nt
    buffer_load_dwordx4 v[108:111], v11, s[44:47], s9 offen nt
    s_add_u32 s9, s9, 9216
    v_perm_b32 v9, v97, v97, s7
    v_and_b32 v60, v2, v9
    v_and_b32 v61, v3, v9
    v_and_b32 v62, v4, v9
    v_and_b32 v63, v5, v9
    s_waitcnt vmcnt(2)
    s_nop 0
    v_mfma_f32_16x16x32_bf16 v[48:51], v[112:115], v[60:63], v[48:51]
    v_mfma_f32_16x16x32_bf16 v[52:55], v[116:119], v[60:63], v[52:55]
    buffer_load_dwordx4 v[112:115], v11, s[40:43], s9 offen nt
    buffer_load_dwordx4 v[116:119], v11, s[44:47], s9 offen nt
    s_add_u32 s9, s9, 9216
    v_perm_b32 v9, v98, v98, s6
    v_and_b32 v56, v2, v9
    v_and_b32 v57, v3, v9
    v_and_b32 v58, v4, v9
    v_and_b32 v59, v5, v9
    s_waitcnt vmcnt(2)
    s_nop 0
    v_mfma_f32_16x16x32_bf16 v[48:51], v[104:107], v[56:59], v[48:51]
    v_mfma_f32_16x16x32_bf16 v[52:55], v[108:111], v[56:59], v[52:55]
    buffer_load_dwordx4 v[104:107], v11, s[40:43], s9 offen nt
    buffer_load_dwordx4 v[108:111], v11, s[44:47], s9 offen nt
    s_add_u32 s9, s9, 9216
    v_perm_b32 v9, v98, v98, s7
    v_and_b32 v60, v2, v9
    v_and_b32 v61, v3, v9
    v_and_b32 v62, v4, v9
    v_and_b32 v63, v5, v9
    s_waitcnt vmcnt(2)
    s_nop 0
    v_mfma_f32_16x16x32_bf16 v[48:51], v[112:115], v[60:63], v[48:51]
    v_mfma_f32_16x16x32_bf16 v[52:55], v[116:119], v[60:63], v[52:55]
    buffer_load_dwordx4 v[112:115], v11, s[40:43], s9 offen nt
    buffer_load_dwordx4 v[116:119], v11, s[44:47], s9 offen nt
    s_add_u32 s9, s9, 9216
    v_perm_b32 v9, v99, v99, s6
    v_and_b32 v56, v2, v9
    v_and_b32 v57, v3, v9
    v_and_b32 v58, v4, v9
    v_and_b32 v59, v5, v9
    s_waitcnt vmcnt(2)
    s_nop 0
    v_mfma_f32_16x16x32_bf16 v[48:51], v[104:107], v[56:59], v[48:51]
    v_mfma_f32_16x16x32_bf16 v[52:55], v[108:111], v[56:59], v[52:55]
    v_perm_b32 v9, v99, v99, s7
    v_and_b32 v60, v2, v9
    v_and_b32 v61, v3, v9
    v_and_b32 v62, v4, v9
    v_and_b32 v63, v5, v9
    s_waitcnt vmcnt(0)
    s_nop 0
    v_mfma_f32_16x16x32_bf16 v[48:51], v[112:115], v[60:63], v[48:51]
    v_mfma_f32_16x16x32_bf16 v[52:55], v[116:119], v[60:63], v[52:55]
    v_and_b32 v9, 1, v0
    v_lshl_add_u32 v9, v6, 1, v9
    v_mul_u32_u24 v11, 9216, v9
    v_bfe_u32 v10, v0, 1, 3
    v_lshl_add_u32 v11, v10, 4, v11
    s_mul_i32 s9, s78, 73728
    buffer_load_dwordx4 v[104:107], v11, s[48:51], s9 offen offset:0 nt
    buffer_load_dwordx4 v[108:111], v11, s[48:51], s9 offen offset:128 nt
    buffer_load_dwordx4 v[112:115], v11, s[48:51], s9 offen offset:256 nt
    buffer_load_dwordx4 v[116:119], v11, s[48:51], s9 offen offset:384 nt
    buffer_load_dwordx4 v[120:123], v11, s[48:51], s9 offen offset:512 nt
    buffer_load_dwordx4 v[124:127], v11, s[48:51], s9 offen offset:640 nt
    buffer_load_dwordx4 v[128:131], v11, s[48:51], s9 offen offset:768 nt
    buffer_load_dwordx4 v[132:135], v11, s[48:51], s9 offen offset:896 nt
    buffer_load_dwordx4 v[136:139], v11, s[48:51], s9 offen offset:1024 nt
    s_add_u32 s9, s9, 1152
    v_cndmask_b32 v12, v48, v51, s[14:15]
    v_cndmask_b32 v14, v50, v49, s[14:15]
    s_nop 1
    v_add_f32_dpp v12, v14, v12 row_ror:8 row_mask:0xf bank_mask:0xf
    v_cndmask_b32 v13, v52, v55, s[14:15]
    v_cndmask_b32 v14, v54, v53, s[14:15]
    s_nop 1
    v_add_f32_dpp v13, v14, v13 row_ror:8 row_mask:0xf bank_mask:0xf
    v_cvt_pk_bf16_f32 v12, v12, v12
    v_lshlrev_b32 v12, 16, v12
    v_cvt_pk_bf16_f32 v13, v13, v13
    v_lshlrev_b32 v13, 16, v13
    v_mul_f32 v14, v12, v12
    v_mul_f32 v14, 0x3d372713, v14
    v_fma_f32 v14, v14, v12, v12
    v_mul_f32 v14, 0xc0135761, v14
    v_exp_f32 v14, v14
    s_nop 0
    v_add_f32 v14, 1.0, v14
    v_rcp_f32 v14, v14
    s_nop 0
    v_mul_f32 v12, v12, v14
    v_cvt_pk_bf16_f32 v12, v12, v12
    v_lshlrev_b32 v12, 16, v12
    v_mul_f32 v12, v12, v13
    v_cvt_pk_bf16_f32 v12, v12, v12
    v_lshlrev_b32 v14, 1, v0
    ds_write_b16 v14, v12 offset:1792
    v_lshrrev_b32 v14, 3, v0
    v_lshlrev_b32 v14, 4, v14
    s_waitcnt lgkmcnt(0)
    ds_read_b128 v[16:19], v14 offset:1792
    s_waitcnt lgkmcnt(0)
    v_perm_b32 v9, v16, v16, s6
    v_and_b32 v56, v2, v9
    v_and_b32 v57, v3, v9
    v_and_b32 v58, v4, v9
    v_and_b32 v59, v5, v9
    buffer_load_dwordx4 v[140:143], v11, s[48:51], s9 offen offset:0 nt
    buffer_load_dwordx4 v[144:147], v11, s[48:51], s9 offen offset:128 nt
    buffer_load_dwordx4 v[148:151], v11, s[48:51], s9 offen offset:256 nt
    buffer_load_dwordx4 v[152:155], v11, s[48:51], s9 offen offset:384 nt
    buffer_load_dwordx4 v[156:159], v11, s[48:51], s9 offen offset:512 nt
    buffer_load_dwordx4 v[160:163], v11, s[48:51], s9 offen offset:640 nt
    buffer_load_dwordx4 v[164:167], v11, s[48:51], s9 offen offset:768 nt
    buffer_load_dwordx4 v[168:171], v11, s[48:51], s9 offen offset:896 nt
    buffer_load_dwordx4 v[172:175], v11, s[48:51], s9 offen offset:1024 nt
    s_add_u32 s9, s9, 1152
    s_waitcnt vmcnt(9)
    s_nop 0
    v_mfma_f32_16x16x32_bf16 v[64:67], v[104:107], v[56:59], 0
    v_mfma_f32_16x16x32_bf16 v[68:71], v[108:111], v[56:59], 0
    v_mfma_f32_16x16x32_bf16 v[72:75], v[112:115], v[56:59], 0
    v_mfma_f32_16x16x32_bf16 v[76:79], v[116:119], v[56:59], 0
    v_mfma_f32_16x16x32_bf16 v[80:83], v[120:123], v[56:59], 0
    v_mfma_f32_16x16x32_bf16 v[84:87], v[124:127], v[56:59], 0
    v_mfma_f32_16x16x32_bf16 v[88:91], v[128:131], v[56:59], 0
    v_mfma_f32_16x16x32_bf16 v[92:95], v[132:135], v[56:59], 0
    v_mfma_f32_16x16x32_bf16 v[96:99], v[136:139], v[56:59], 0
    v_perm_b32 v9, v16, v16, s7
    v_and_b32 v60, v2, v9
    v_and_b32 v61, v3, v9
    v_and_b32 v62, v4, v9
    v_and_b32 v63, v5, v9
    buffer_load_dwordx4 v[104:107], v11, s[48:51], s9 offen offset:0 nt
    buffer_load_dwordx4 v[108:111], v11, s[48:51], s9 offen offset:128 nt
    buffer_load_dwordx4 v[112:115], v11, s[48:51], s9 offen offset:256 nt
    buffer_load_dwordx4 v[116:119], v11, s[48:51], s9 offen offset:384 nt
    buffer_load_dwordx4 v[120:123], v11, s[48:51], s9 offen offset:512 nt
    buffer_load_dwordx4 v[124:127], v11, s[48:51], s9 offen offset:640 nt
    buffer_load_dwordx4 v[128:131], v11, s[48:51], s9 offen offset:768 nt
    buffer_load_dwordx4 v[132:135], v11, s[48:51], s9 offen offset:896 nt
    buffer_load_dwordx4 v[136:139], v11, s[48:51], s9 offen offset:1024 nt
    s_add_u32 s9, s9, 1152
    s_waitcnt vmcnt(9)
    s_nop 0
    v_mfma_f32_16x16x32_bf16 v[64:67], v[140:143], v[60:63], v[64:67]
    v_mfma_f32_16x16x32_bf16 v[68:71], v[144:147], v[60:63], v[68:71]
    v_mfma_f32_16x16x32_bf16 v[72:75], v[148:151], v[60:63], v[72:75]
    v_mfma_f32_16x16x32_bf16 v[76:79], v[152:155], v[60:63], v[76:79]
    v_mfma_f32_16x16x32_bf16 v[80:83], v[156:159], v[60:63], v[80:83]
    v_mfma_f32_16x16x32_bf16 v[84:87], v[160:163], v[60:63], v[84:87]
    v_mfma_f32_16x16x32_bf16 v[88:91], v[164:167], v[60:63], v[88:91]
    v_mfma_f32_16x16x32_bf16 v[92:95], v[168:171], v[60:63], v[92:95]
    v_mfma_f32_16x16x32_bf16 v[96:99], v[172:175], v[60:63], v[96:99]
    v_perm_b32 v9, v17, v17, s6
    v_and_b32 v56, v2, v9
    v_and_b32 v57, v3, v9
    v_and_b32 v58, v4, v9
    v_and_b32 v59, v5, v9
    buffer_load_dwordx4 v[140:143], v11, s[48:51], s9 offen offset:0 nt
    buffer_load_dwordx4 v[144:147], v11, s[48:51], s9 offen offset:128 nt
    buffer_load_dwordx4 v[148:151], v11, s[48:51], s9 offen offset:256 nt
    buffer_load_dwordx4 v[152:155], v11, s[48:51], s9 offen offset:384 nt
    buffer_load_dwordx4 v[156:159], v11, s[48:51], s9 offen offset:512 nt
    buffer_load_dwordx4 v[160:163], v11, s[48:51], s9 offen offset:640 nt
    buffer_load_dwordx4 v[164:167], v11, s[48:51], s9 offen offset:768 nt
    buffer_load_dwordx4 v[168:171], v11, s[48:51], s9 offen offset:896 nt
    buffer_load_dwordx4 v[172:175], v11, s[48:51], s9 offen offset:1024 nt
    s_add_u32 s9, s9, 1152
    s_waitcnt vmcnt(9)
    s_nop 0
    v_mfma_f32_16x16x32_bf16 v[64:67], v[104:107], v[56:59], v[64:67]
    v_mfma_f32_16x16x32_bf16 v[68:71], v[108:111], v[56:59], v[68:71]
    v_mfma_f32_16x16x32_bf16 v[72:75], v[112:115], v[56:59], v[72:75]
    v_mfma_f32_16x16x32_bf16 v[76:79], v[116:119], v[56:59], v[76:79]
    v_mfma_f32_16x16x32_bf16 v[80:83], v[120:123], v[56:59], v[80:83]
    v_mfma_f32_16x16x32_bf16 v[84:87], v[124:127], v[56:59], v[84:87]
    v_mfma_f32_16x16x32_bf16 v[88:91], v[128:131], v[56:59], v[88:91]
    v_mfma_f32_16x16x32_bf16 v[92:95], v[132:135], v[56:59], v[92:95]
    v_mfma_f32_16x16x32_bf16 v[96:99], v[136:139], v[56:59], v[96:99]
    v_perm_b32 v9, v17, v17, s7
    v_and_b32 v60, v2, v9
    v_and_b32 v61, v3, v9
    v_and_b32 v62, v4, v9
    v_and_b32 v63, v5, v9
    buffer_load_dwordx4 v[104:107], v11, s[48:51], s9 offen offset:0 nt
    buffer_load_dwordx4 v[108:111], v11, s[48:51], s9 offen offset:128 nt
    buffer_load_dwordx4 v[112:115], v11, s[48:51], s9 offen offset:256 nt
    buffer_load_dwordx4 v[116:119], v11, s[48:51], s9 offen offset:384 nt
    buffer_load_dwordx4 v[120:123], v11, s[48:51], s9 offen offset:512 nt
    buffer_load_dwordx4 v[124:127], v11, s[48:51], s9 offen offset:640 nt
    buffer_load_dwordx4 v[128:131], v11, s[48:51], s9 offen offset:768 nt
    buffer_load_dwordx4 v[132:135], v11, s[48:51], s9 offen offset:896 nt
    buffer_load_dwordx4 v[136:139], v11, s[48:51], s9 offen offset:1024 nt
    s_add_u32 s9, s9, 1152
    s_waitcnt vmcnt(9)
    s_nop 0
    v_mfma_f32_16x16x32_bf16 v[64:67], v[140:143], v[60:63], v[64:67]
    v_mfma_f32_16x16x32_bf16 v[68:71], v[144:147], v[60:63], v[68:71]
    v_mfma_f32_16x16x32_bf16 v[72:75], v[148:151], v[60:63], v[72:75]
    v_mfma_f32_16x16x32_bf16 v[76:79], v[152:155], v[60:63], v[76:79]
    v_mfma_f32_16x16x32_bf16 v[80:83], v[156:159], v[60:63], v[80:83]
    v_mfma_f32_16x16x32_bf16 v[84:87], v[160:163], v[60:63], v[84:87]
    v_mfma_f32_16x16x32_bf16 v[88:91], v[164:167], v[60:63], v[88:91]
    v_mfma_f32_16x16x32_bf16 v[92:95], v[168:171], v[60:63], v[92:95]
    v_mfma_f32_16x16x32_bf16 v[96:99], v[172:175], v[60:63], v[96:99]
    v_perm_b32 v9, v18, v18, s6
    v_and_b32 v56, v2, v9
    v_and_b32 v57, v3, v9
    v_and_b32 v58, v4, v9
    v_and_b32 v59, v5, v9
    buffer_load_dwordx4 v[140:143], v11, s[48:51], s9 offen offset:0 nt
    buffer_load_dwordx4 v[144:147], v11, s[48:51], s9 offen offset:128 nt
    buffer_load_dwordx4 v[148:151], v11, s[48:51], s9 offen offset:256 nt
    buffer_load_dwordx4 v[152:155], v11, s[48:51], s9 offen offset:384 nt
    buffer_load_dwordx4 v[156:159], v11, s[48:51], s9 offen offset:512 nt
    buffer_load_dwordx4 v[160:163], v11, s[48:51], s9 offen offset:640 nt
    buffer_load_dwordx4 v[164:167], v11, s[48:51], s9 offen offset:768 nt
    buffer_load_dwordx4 v[168:171], v11, s[48:51], s9 offen offset:896 nt
    buffer_load_dwordx4 v[172:175], v11, s[48:51], s9 offen offset:1024 nt
    s_add_u32 s9, s9, 1152
    s_waitcnt vmcnt(9)
    s_nop 0
    v_mfma_f32_16x16x32_bf16 v[64:67], v[104:107], v[56:59], v[64:67]
    v_mfma_f32_16x16x32_bf16 v[68:71], v[108:111], v[56:59], v[68:71]
    v_mfma_f32_16x16x32_bf16 v[72:75], v[112:115], v[56:59], v[72:75]
    v_mfma_f32_16x16x32_bf16 v[76:79], v[116:119], v[56:59], v[76:79]
    v_mfma_f32_16x16x32_bf16 v[80:83], v[120:123], v[56:59], v[80:83]
    v_mfma_f32_16x16x32_bf16 v[84:87], v[124:127], v[56:59], v[84:87]
    v_mfma_f32_16x16x32_bf16 v[88:91], v[128:131], v[56:59], v[88:91]
    v_mfma_f32_16x16x32_bf16 v[92:95], v[132:135], v[56:59], v[92:95]
    v_mfma_f32_16x16x32_bf16 v[96:99], v[136:139], v[56:59], v[96:99]
    v_perm_b32 v9, v18, v18, s7
    v_and_b32 v60, v2, v9
    v_and_b32 v61, v3, v9
    v_and_b32 v62, v4, v9
    v_and_b32 v63, v5, v9
    buffer_load_dwordx4 v[104:107], v11, s[48:51], s9 offen offset:0 nt
    buffer_load_dwordx4 v[108:111], v11, s[48:51], s9 offen offset:128 nt
    buffer_load_dwordx4 v[112:115], v11, s[48:51], s9 offen offset:256 nt
    buffer_load_dwordx4 v[116:119], v11, s[48:51], s9 offen offset:384 nt
    buffer_load_dwordx4 v[120:123], v11, s[48:51], s9 offen offset:512 nt
    buffer_load_dwordx4 v[124:127], v11, s[48:51], s9 offen offset:640 nt
    buffer_load_dwordx4 v[128:131], v11, s[48:51], s9 offen offset:768 nt
    buffer_load_dwordx4 v[132:135], v11, s[48:51], s9 offen offset:896 nt
    buffer_load_dwordx4 v[136:139], v11, s[48:51], s9 offen offset:1024 nt
    s_add_u32 s9, s9, 1152
    s_waitcnt vmcnt(9)
    s_nop 0
    v_mfma_f32_16x16x32_bf16 v[64:67], v[140:143], v[60:63], v[64:67]
    v_mfma_f32_16x16x32_bf16 v[68:71], v[144:147], v[60:63], v[68:71]
    v_mfma_f32_16x16x32_bf16 v[72:75], v[148:151], v[60:63], v[72:75]
    v_mfma_f32_16x16x32_bf16 v[76:79], v[152:155], v[60:63], v[76:79]
    v_mfma_f32_16x16x32_bf16 v[80:83], v[156:159], v[60:63], v[80:83]
    v_mfma_f32_16x16x32_bf16 v[84:87], v[160:163], v[60:63], v[84:87]
    v_mfma_f32_16x16x32_bf16 v[88:91], v[164:167], v[60:63], v[88:91]
    v_mfma_f32_16x16x32_bf16 v[92:95], v[168:171], v[60:63], v[92:95]
    v_mfma_f32_16x16x32_bf16 v[96:99], v[172:175], v[60:63], v[96:99]
    v_perm_b32 v9, v19, v19, s6
    v_and_b32 v56, v2, v9
    v_and_b32 v57, v3, v9
    v_and_b32 v58, v4, v9
    v_and_b32 v59, v5, v9
    buffer_load_dwordx4 v[140:143], v11, s[48:51], s9 offen offset:0 nt
    buffer_load_dwordx4 v[144:147], v11, s[48:51], s9 offen offset:128 nt
    buffer_load_dwordx4 v[148:151], v11, s[48:51], s9 offen offset:256 nt
    buffer_load_dwordx4 v[152:155], v11, s[48:51], s9 offen offset:384 nt
    buffer_load_dwordx4 v[156:159], v11, s[48:51], s9 offen offset:512 nt
    buffer_load_dwordx4 v[160:163], v11, s[48:51], s9 offen offset:640 nt
    buffer_load_dwordx4 v[164:167], v11, s[48:51], s9 offen offset:768 nt
    buffer_load_dwordx4 v[168:171], v11, s[48:51], s9 offen offset:896 nt
    buffer_load_dwordx4 v[172:175], v11, s[48:51], s9 offen offset:1024 nt
    s_add_u32 s9, s9, 1152
    s_waitcnt vmcnt(9)
    s_nop 0
    v_mfma_f32_16x16x32_bf16 v[64:67], v[104:107], v[56:59], v[64:67]
    v_mfma_f32_16x16x32_bf16 v[68:71], v[108:111], v[56:59], v[68:71]
    v_mfma_f32_16x16x32_bf16 v[72:75], v[112:115], v[56:59], v[72:75]
    v_mfma_f32_16x16x32_bf16 v[76:79], v[116:119], v[56:59], v[76:79]
    v_mfma_f32_16x16x32_bf16 v[80:83], v[120:123], v[56:59], v[80:83]
    v_mfma_f32_16x16x32_bf16 v[84:87], v[124:127], v[56:59], v[84:87]
    v_mfma_f32_16x16x32_bf16 v[88:91], v[128:131], v[56:59], v[88:91]
    v_mfma_f32_16x16x32_bf16 v[92:95], v[132:135], v[56:59], v[92:95]
    v_mfma_f32_16x16x32_bf16 v[96:99], v[136:139], v[56:59], v[96:99]
    v_perm_b32 v9, v19, v19, s7
    v_and_b32 v60, v2, v9
    v_and_b32 v61, v3, v9
    v_and_b32 v62, v4, v9
    v_and_b32 v63, v5, v9
    s_waitcnt vmcnt(0)
    s_nop 0
    v_mfma_f32_16x16x32_bf16 v[64:67], v[140:143], v[60:63], v[64:67]
    v_mfma_f32_16x16x32_bf16 v[68:71], v[144:147], v[60:63], v[68:71]
    v_mfma_f32_16x16x32_bf16 v[72:75], v[148:151], v[60:63], v[72:75]
    v_mfma_f32_16x16x32_bf16 v[76:79], v[152:155], v[60:63], v[76:79]
    v_mfma_f32_16x16x32_bf16 v[80:83], v[156:159], v[60:63], v[80:83]
    v_mfma_f32_16x16x32_bf16 v[84:87], v[160:163], v[60:63], v[84:87]
    v_mfma_f32_16x16x32_bf16 v[88:91], v[164:167], v[60:63], v[88:91]
    v_mfma_f32_16x16x32_bf16 v[92:95], v[168:171], v[60:63], v[92:95]
    v_mfma_f32_16x16x32_bf16 v[96:99], v[172:175], v[60:63], v[96:99]
    v_lshlrev_b32 v14, 3, v0
    s_lshl_b32 s9, s78, 9
    s_add_u32 s9, s9, 1245184
    v_mov_b32 v21, s79
    v_mov_b32 v23, s79
    v_mov_b32 v25, s79
    v_mov_b32 v27, s79
    v_mov_b32 v29, s79
    v_mov_b32 v31, s79
    v_mov_b32 v33, s79
    v_mov_b32 v35, s79
    v_mov_b32 v37, s79
    v_cndmask_b32 v20, v64, v67, s[14:15]
    v_cndmask_b32 v15, v66, v65, s[14:15]
    s_nop 1
    v_add_f32_dpp v20, v15, v20 row_ror:8 row_mask:0xf bank_mask:0xf
    buffer_store_dwordx2 v[20:21], v14, s[52:55], s9 offen sc1
    s_add_u32 s9, s9, 36864
    v_cndmask_b32 v22, v68, v71, s[14:15]
    v_cndmask_b32 v15, v70, v69, s[14:15]
    s_nop 1
    v_add_f32_dpp v22, v15, v22 row_ror:8 row_mask:0xf bank_mask:0xf
    buffer_store_dwordx2 v[22:23], v14, s[52:55], s9 offen sc1
    s_add_u32 s9, s9, 36864
    v_cndmask_b32 v24, v72, v75, s[14:15]
    v_cndmask_b32 v15, v74, v73, s[14:15]
    s_nop 1
    v_add_f32_dpp v24, v15, v24 row_ror:8 row_mask:0xf bank_mask:0xf
    buffer_store_dwordx2 v[24:25], v14, s[52:55], s9 offen sc1
    s_add_u32 s9, s9, 36864
    v_cndmask_b32 v26, v76, v79, s[14:15]
    v_cndmask_b32 v15, v78, v77, s[14:15]
    s_nop 1
    v_add_f32_dpp v26, v15, v26 row_ror:8 row_mask:0xf bank_mask:0xf
    buffer_store_dwordx2 v[26:27], v14, s[52:55], s9 offen sc1
    s_add_u32 s9, s9, 36864
    v_cndmask_b32 v28, v80, v83, s[14:15]
    v_cndmask_b32 v15, v82, v81, s[14:15]
    s_nop 1
    v_add_f32_dpp v28, v15, v28 row_ror:8 row_mask:0xf bank_mask:0xf
    buffer_store_dwordx2 v[28:29], v14, s[52:55], s9 offen sc1
    s_add_u32 s9, s9, 36864
    v_cndmask_b32 v30, v84, v87, s[14:15]
    v_cndmask_b32 v15, v86, v85, s[14:15]
    s_nop 1
    v_add_f32_dpp v30, v15, v30 row_ror:8 row_mask:0xf bank_mask:0xf
    buffer_store_dwordx2 v[30:31], v14, s[52:55], s9 offen sc1
    s_add_u32 s9, s9, 36864
    v_cndmask_b32 v32, v88, v91, s[14:15]
    v_cndmask_b32 v15, v90, v89, s[14:15]
    s_nop 1
    v_add_f32_dpp v32, v15, v32 row_ror:8 row_mask:0xf bank_mask:0xf
    buffer_store_dwordx2 v[32:33], v14, s[52:55], s9 offen sc1
    s_add_u32 s9, s9, 36864
    v_cndmask_b32 v34, v92, v95, s[14:15]
    v_cndmask_b32 v15, v94, v93, s[14:15]
    s_nop 1
    v_add_f32_dpp v34, v15, v34 row_ror:8 row_mask:0xf bank_mask:0xf
    buffer_store_dwordx2 v[34:35], v14, s[52:55], s9 offen sc1
    s_add_u32 s9, s9, 36864
    v_cndmask_b32 v36, v96, v99, s[14:15]
    v_cndmask_b32 v15, v98, v97, s[14:15]
    s_nop 1
    v_add_f32_dpp v36, v15, v36 row_ror:8 row_mask:0xf bank_mask:0xf
    buffer_store_dwordx2 v[36:37], v14, s[52:55], s9 offen sc1
    s_add_u32 s9, s9, 36864
L_end:
    s_endpgm
L_exit:
    s_endpgm
.section .rodata,"a"
.p2align 6
.amdhsa_kernel recurrent_scan__gqa_block_cached__geglu_ffn__decode_kernel
  .amdhsa_next_free_vgpr 256
  .amdhsa_next_free_sgpr 96
  .amdhsa_accum_offset 256
  .amdhsa_group_segment_fixed_size 0
  .amdhsa_kernarg_size 96
  .amdhsa_user_sgpr_count 2
  .amdhsa_user_sgpr_kernarg_segment_ptr 1
  .amdhsa_system_sgpr_workgroup_id_x 1
  .amdhsa_float_denorm_mode_32 3
.end_amdhsa_kernel
```
